```python
import torch

def _softmax(x, axis=-1):
    return torch.softmax(x, dim=axis)
def _gelu(x):
    return torch.nn.functional.gelu(x, approximate="tanh")
def _silu(x):
    return torch.nn.functional.silu(x)
def _sigmoid(x):
    return torch.sigmoid(x)
def _layernorm(x, axis=-1, eps=1e-5):
    m = x.mean(dim=axis, keepdim=True)
    v = x.var(dim=axis, keepdim=True, unbiased=False)
    return (x - m) / torch.sqrt(v + eps)
def _scatter_add(tgt, idx, src, axis=0):
    return tgt.clone().index_add_(axis, idx, src)
def _segment_sum(src, seg, n):
    out = torch.zeros((n,) + src.shape[1:], dtype=src.dtype)
    return out.index_add_(0, seg, src)
def _pad(x, pw):
    flat = tuple(v for pair in reversed(pw) for v in pair)
    return torch.nn.functional.pad(x, flat)

kernel_name = 'recurrent_scan__sliding_block_cached__glu_gated_bilinear__decode'

def setup_inputs():

    _w = (lambda a: (lambda t: t.to(torch.bfloat16) if t.is_floating_point() else t)(torch.as_tensor(a)))
    def _A_setup():
        B, Sq, D = 8, 1, 576
        Hq, Hkv, Sk, Dh = 32, 16, 4096, 128
        assert Hq % Hkv == 0, (Hq, Hkv)
        return {
            "x": _w((lambda *s: torch.randn(*s, dtype=torch.bfloat16) * 0.05)(B, Sq, D)),
            "k_cache": _w((lambda *s: torch.randn(*s, dtype=torch.bfloat16) * 3.2)(B, Hkv, Sk, Dh)),
            "v_cache": _w((lambda *s: torch.randn(*s, dtype=torch.bfloat16) * 3.2)(B, Hkv, Sk, Dh)),
            "wq": _w((lambda *s: torch.randn(*s, dtype=torch.bfloat16) * 3.2)(D, Hq * Dh) * (D ** -0.5)),
            "wo": _w((lambda *s: torch.randn(*s, dtype=torch.bfloat16) * 3.2)(Hq * Dh, D) * ((Hq * Dh) ** -0.5)),
        }
    _A_in = _A_setup()

    def _B_setup():
        B, S, D, F = 8, 1, 576, 4608
        return {
            "x": _w((lambda *s: torch.randn(*s, dtype=torch.bfloat16) * 0.05)(B, S, D)),
            "w_gate": _w((lambda *s: torch.randn(*s, dtype=torch.bfloat16) * 0.4)(D, F) * (D ** -0.5)),
            "w_up": _w((lambda *s: torch.randn(*s, dtype=torch.bfloat16) * 0.4)(D, F) * (D ** -0.5)),
            "w_down": _w((lambda *s: torch.randn(*s, dtype=torch.bfloat16) * 0.4)(F, D) * (F ** -0.5)),
        }
    _B_in = _B_setup()

    return {
        "A_x": _A_in["x"],
        "A_k_cache": _A_in["k_cache"],
        "A_v_cache": _A_in["v_cache"],
        "A_wq": _A_in["wq"],
        "A_wo": _A_in["wo"],
        "B_x": _B_in["x"],
        "B_w_gate": _B_in["w_gate"],
        "B_w_up": _B_in["w_up"],
        "B_w_down": _B_in["w_down"],
    }

def reference(A_x, A_k_cache, A_v_cache, A_wq, A_wo, B_x, B_w_gate, B_w_up, B_w_down):
    def _A_ref(x, k_cache, v_cache, wq, wo):
        B, Sq, D = x.shape
        Hq, Dh = 32, 128
        Hkv, Sk = k_cache.shape[1], k_cache.shape[2]
        W = min(4096, max(256, Sk // 4))
        rep = Hq // Hkv
        q = (lambda x, *d: x.permute(*d))((x @ wq).reshape(B, Sq, Hq, Dh), 0, 2, 1, 3)
        k = (lambda x, n, axis: torch.repeat_interleave(x, n, dim=axis))(k_cache[:, :, Sk - W:, :], rep, axis=1)
        v = (lambda x, n, axis: torch.repeat_interleave(x, n, dim=axis))(v_cache[:, :, Sk - W:, :], rep, axis=1)
        scores = torch.einsum("bhqd,bhkd->bhqk", q, k) * (Dh ** -0.5)
        p = _softmax(scores, axis=-1)
        o = torch.einsum("bhqk,bhkd->bhqd", p, v)
        return (lambda x, *d: x.permute(*d))(o, 0, 2, 1, 3).reshape(B, Sq, Hq * Dh) @ wo

    def _B_ref(x, w_gate, w_up, w_down):
        g = torch.einsum("bsd,df->bsf", x, w_gate)
        u = torch.einsum("bsd,df->bsf", x, w_up)
        h = g * u
        return torch.einsum("bsf,fd->bsd", h, w_down)

    x = A_x
    xn = _layernorm(x, axis=-1)
    s = _A_ref(xn, A_k_cache, A_v_cache, A_wq, A_wo)
    g = _silu(_B_ref(xn, B_w_gate, B_w_up, B_w_down))
    return x + s * g
```

```asm
; @launch grid=(256,1,1) block=(512,1,1) lds=142720
.amdgcn_target "amdgcn-amd-amdhsa--gfx950"
.text
.globl recurrent_scan__sliding_block_cached__glu_gated_bilinear__decode_kernel
.p2align 8
.type recurrent_scan__sliding_block_cached__glu_gated_bilinear__decode_kernel,@function
recurrent_scan__sliding_block_cached__glu_gated_bilinear__decode_kernel:
    s_load_dwordx16 s[4:19], s[0:1], 0
    s_load_dwordx8 s[20:27], s[0:1], 64
    s_cmpk_ge_u32 s2, 256
    s_cbranch_scc1 L_end
    s_getpc_b64 s[94:95]
    v_lshlrev_b32 v1, 5, v0
    global_load_dword v127, v1, s[94:95]
    v_readfirstlane_b32 s28, v0
    s_and_b32 s29, s2, 7
    s_lshr_b32 s30, s2, 3
    s_lshl_b32 s29, s29, 2
    s_lshr_b32 s29, 0x76325410, s29
    s_and_b32 s29, s29, 7
    s_cmpk_lt_u32 s28, 256
    s_cbranch_scc1 L_W
    s_bfe_u32 s31, s2, 0x30004
    s_bfe_u32 s3, s2, 0x10003
    s_lshl1_add_u32 s44, s29, s3
    s_lshl4_add_u32 s3, s31, s44
    s_lshr_b32 s45, s2, 7
    s_lshl3_add_u32 s3, s3, s45
    s_add_u32 s3, s3, 6
    s_lshl_b32 s3, s3, 17
    v_and_b32 v1, 0xcc, v0
    v_and_b32 v2, 3, v0
    v_and_b32 v3, 48, v0
    v_lshlrev_b32 v1, 6, v1
    v_lshl_add_u32 v1, v2, 4, v1
    v_lshl_add_u32 v1, v3, 2, v1
    s_mov_b32 s34, 0x20000
    s_mov_b32 s35, s34
    s_and_b32 s46, s30, 7
    s_lshl_b32 s46, s46, 14
    s_waitcnt lgkmcnt(0)
    s_add_u32 s32, s6, s3
    s_addc_u32 s33, s7, 0
    buffer_load_dwordx4 v[128:131], v1, s[32:35], s46 offen offset:0 nt
    buffer_load_dwordx4 v[132:135], v1, s[32:35], s46 offen offset:1024 nt
    s_load_dword s63, s[26:27], 819200
    s_add_u32 s36, s8, s3
    s_addc_u32 s37, s9, 0
    s_mov_b32 s38, s34
    s_mov_b32 s39, s34
    v_and_b32 v2, 63, v0
    v_and_b32 v3, 0xc0, v0
    v_lshlrev_b32 v2, 4, v2
    v_lshl_add_u32 v2, v3, 6, v2
    v_mov_b32 v7, 133696
    v_mov_b32 v6, 1
    s_mov_b32 s48, 0xaaaaaaaa
    s_mov_b32 s49, s48
    s_mov_b32 s50, 0xcccccccc
    s_mov_b32 s51, s50
    s_mov_b32 s52, 0xf0f0f0f0
    s_mov_b32 s53, s52
    v_mov_b32 v3, 0xffff
    v_mov_b32 v4, 0xffff0000
    v_cndmask_b32 v3, v3, v4, s[48:49]
    v_bfe_u32 v4, v0, 1, 2
    v_cmp_eq_u32 vcc, 0, v4
    s_nop 1
    v_cndmask_b32 v44, 0, v3, vcc
    v_cmp_eq_u32 vcc, 1, v4
    s_nop 1
    v_cndmask_b32 v45, 0, v3, vcc
    v_cmp_eq_u32 vcc, 2, v4
    s_nop 1
    v_cndmask_b32 v46, 0, v3, vcc
    v_cmp_eq_u32 vcc, 3, v4
    s_nop 1
    v_cndmask_b32 v47, 0, v3, vcc
    v_bfe_u32 v3, v0, 3, 1
    v_bfe_u32 v4, v0, 4, 2
    v_and_b32 v5, 3, v0
    v_lshl_add_u32 v60, v4, 2, v5
    v_lshlrev_b32 v60, 4, v60
    v_lshl_add_u32 v60, v3, 8, v60
    v_add_u32 v60, 124928, v60
    v_lshl_add_u32 v62, v3, 2, v4
    v_lshlrev_b32 v62, 7, v62
    v_bfe_u32 v63, v0, 6, 2
    v_lshl_add_u32 v62, v63, 10, v62
    v_add_u32 v62, 125440, v62
    v_lshl_add_u32 v61, v5, 3, v62
    v_and_b32 v4, 4, v0
    v_add_u32 v61, v4, v61
    v_lshl_add_u32 v63, v3, 2, v63
    v_lshlrev_b32 v63, 3, v63
    v_add_u32 v63, 133632, v63
    v_lshl_add_u32 v64, v3, 2, v5
    v_lshlrev_b32 v64, 3, v64
    v_add_u32 v64, 133632, v64
    v_and_b32 v65, 0xff, v0
    v_lshlrev_b32 v65, 4, v65
    v_add_u32 v65, 129536, v65
    s_lshl4_add_u32 s47, s44, s31
    s_lshl3_add_u32 s47, s45, s47
    v_bfe_u32 v4, v0, 5, 3
    s_lshl_b32 s3, s47, 10
    s_add_u32 s3, s3, 524288
    v_lshl_add_u32 v4, v4, 7, s3
    global_load_dword v126, v4, s[26:27] sc1
    s_mov_b32 s40, 37748736
    s_cmp_eq_u32 s29, 3
    s_cselect_b32 s40, 56623104, s40
    s_waitcnt lgkmcnt(0)
    s_barrier
    s_mul_i32 s63, s63, 0x9e3779b1
    s_add_u32 s63, s63, 0x7f4a7c15
    v_mov_b32 v69, s63
    v_mov_b32 v71, s63
    s_mov_b32 s62, 0x400000
L_spin_1:
    ds_read_b32 v3, v7 offset:28
    s_sub_u32 s62, s62, 1
    s_cbranch_scc1 L_spun_2
    s_waitcnt lgkmcnt(0)
    v_readfirstlane_b32 s3, v3
    s_nop 0
    s_cmp_lt_u32 s3, 4
    s_cbranch_scc1 L_spin_1
L_spun_2:
    s_waitcnt lgkmcnt(0)
L_A_nohold:
    s_or_b32 s40, s40, 4228382720
    s_bitcmp1_b32 s40, s30
    s_cselect_b64 s[42:43], -1, 0
    s_mov_b64 vcc, s[42:43]
    buffer_load_dwordx4 v[136:139], v1, s[32:35], s46 offen offset:2048 nt
    s_cbranch_vccnz L_deep_3
    s_waitcnt vmcnt(4)
L_deep_3:
    buffer_load_dwordx4 v[140:143], v1, s[32:35], s46 offen offset:3072 nt
    s_addk_i32 s46, 16384
    s_bitset0_b32 s46, 17
    s_cbranch_vccnz L_deep_4
    s_waitcnt vmcnt(4)
L_deep_4:
    buffer_load_dwordx4 v[144:147], v1, s[32:35], s46 offen offset:0 nt
    s_cbranch_vccnz L_deep_5
    s_waitcnt vmcnt(4)
L_deep_5:
    buffer_load_dwordx4 v[148:151], v1, s[32:35], s46 offen offset:1024 nt
    s_cbranch_vccnz L_deep_6
    s_waitcnt vmcnt(4)
L_deep_6:
    buffer_load_dwordx4 v[152:155], v1, s[32:35], s46 offen offset:2048 nt
    s_cbranch_vccnz L_deep_7
    s_waitcnt vmcnt(4)
L_deep_7:
    s_waitcnt vmcnt(8)
    buffer_load_dwordx4 v[156:159], v1, s[32:35], s46 offen offset:3072 nt
    s_addk_i32 s46, 16384
    s_bitset0_b32 s46, 17
    s_cbranch_vccnz L_deep_8
    s_waitcnt vmcnt(4)
L_deep_8:
    s_waitcnt vmcnt(8)
    buffer_load_dwordx4 v[160:163], v1, s[32:35], s46 offen offset:0 nt
    s_cbranch_vccnz L_deep_9
    s_waitcnt vmcnt(4)
L_deep_9:
    s_waitcnt vmcnt(8)
    buffer_load_dwordx4 v[164:167], v1, s[32:35], s46 offen offset:1024 nt
    s_cbranch_vccnz L_deep_10
    s_waitcnt vmcnt(4)
L_deep_10:
    s_waitcnt vmcnt(8)
    buffer_load_dwordx4 v[168:171], v1, s[32:35], s46 offen offset:2048 nt
    s_cbranch_vccnz L_deep_11
    s_waitcnt vmcnt(4)
L_deep_11:
    s_waitcnt vmcnt(8)
    buffer_load_dwordx4 v[172:175], v1, s[32:35], s46 offen offset:3072 nt
    s_addk_i32 s46, 16384
    s_bitset0_b32 s46, 17
    s_cbranch_vccnz L_deep_12
    s_waitcnt vmcnt(4)
L_deep_12:
    s_waitcnt vmcnt(8)
    buffer_load_dwordx4 v[176:179], v1, s[32:35], s46 offen offset:0 nt
    s_cbranch_vccnz L_deep_13
    s_waitcnt vmcnt(4)
L_deep_13:
    s_waitcnt vmcnt(8)
    buffer_load_dwordx4 v[180:183], v1, s[32:35], s46 offen offset:1024 nt
    s_cbranch_vccnz L_deep_14
    s_waitcnt vmcnt(4)
L_deep_14:
    s_waitcnt vmcnt(8)
    buffer_load_dwordx4 v[184:187], v1, s[32:35], s46 offen offset:2048 nt
    s_cbranch_vccnz L_deep_15
    s_waitcnt vmcnt(4)
L_deep_15:
    s_waitcnt vmcnt(8)
    buffer_load_dwordx4 v[188:191], v1, s[32:35], s46 offen offset:3072 nt
    s_addk_i32 s46, 16384
    s_bitset0_b32 s46, 17
    s_cbranch_vccnz L_deep_16
    s_waitcnt vmcnt(4)
L_deep_16:
    s_waitcnt vmcnt(8)
    buffer_load_dwordx4 v[192:195], v1, s[32:35], s46 offen offset:0 nt
    s_cbranch_vccnz L_deep_17
    s_waitcnt vmcnt(4)
L_deep_17:
    s_waitcnt vmcnt(8)
    buffer_load_dwordx4 v[196:199], v1, s[32:35], s46 offen offset:1024 nt
    s_cbranch_vccnz L_deep_18
    s_waitcnt vmcnt(4)
L_deep_18:
    s_waitcnt vmcnt(8)
    buffer_load_dwordx4 v[200:203], v1, s[32:35], s46 offen offset:2048 nt
    s_cbranch_vccnz L_deep_19
    s_waitcnt vmcnt(4)
L_deep_19:
    s_waitcnt vmcnt(8)
    buffer_load_dwordx4 v[204:207], v1, s[32:35], s46 offen offset:3072 nt
    s_addk_i32 s46, 16384
    s_bitset0_b32 s46, 17
    s_cbranch_vccnz L_deep_20
    s_waitcnt vmcnt(4)
L_deep_20:
    s_waitcnt vmcnt(8)
    buffer_load_dwordx4 v[208:211], v1, s[32:35], s46 offen offset:0 nt
    s_cbranch_vccnz L_deep_21
    s_waitcnt vmcnt(4)
L_deep_21:
    s_waitcnt vmcnt(8)
    buffer_load_dwordx4 v[212:215], v1, s[32:35], s46 offen offset:1024 nt
    s_cbranch_vccnz L_deep_22
    s_waitcnt vmcnt(4)
L_deep_22:
    s_waitcnt vmcnt(8)
    buffer_load_dwordx4 v[216:219], v1, s[32:35], s46 offen offset:2048 nt
    s_cbranch_vccnz L_deep_23
    s_waitcnt vmcnt(4)
L_deep_23:
    s_waitcnt vmcnt(8)
    buffer_load_dwordx4 v[220:223], v1, s[32:35], s46 offen offset:3072 nt
    s_addk_i32 s46, 16384
    s_bitset0_b32 s46, 17
    s_cbranch_vccnz L_deep_24
    s_waitcnt vmcnt(4)
L_deep_24:
    s_waitcnt vmcnt(8)
    buffer_load_dwordx4 v[224:227], v1, s[32:35], s46 offen offset:0 nt
    s_mov_b64 exec, 1
    ds_add_u32 v7, v6 offset:32
    s_mov_b64 exec, -1
    s_cbranch_vccnz L_deep_25
    s_waitcnt vmcnt(4)
L_deep_25:
    s_waitcnt vmcnt(8)
    buffer_load_dwordx4 v[228:231], v1, s[32:35], s46 offen offset:1024 nt
    s_cbranch_vccnz L_deep_26
    s_waitcnt vmcnt(4)
L_deep_26:
    s_cmp_lt_u32 s30, 18
    s_cselect_b64 s[42:43], -1, s[42:43]
    s_mov_b64 vcc, s[42:43]
    s_waitcnt vmcnt(8)
    buffer_load_dwordx4 v[232:235], v1, s[32:35], s46 offen offset:2048 nt
    s_cbranch_vccnz L_deep_27
    s_waitcnt vmcnt(4)
L_deep_27:
    s_waitcnt vmcnt(8)
    buffer_load_dwordx4 v[236:239], v1, s[32:35], s46 offen offset:3072 nt
    s_addk_i32 s46, 16384
    s_bitset0_b32 s46, 17
    s_cbranch_vccnz L_deep_28
    s_waitcnt vmcnt(4)
L_deep_28:
    s_cmp_ge_u32 s30, 26
    s_cselect_b64 s[42:43], 0, s[42:43]
    s_mov_b64 vcc, s[42:43]
    s_waitcnt vmcnt(8)
    buffer_load_dwordx4 v[240:243], v1, s[32:35], s46 offen offset:0 nt
    s_cbranch_vccnz L_deep_29
    s_waitcnt vmcnt(4)
L_deep_29:
    s_waitcnt vmcnt(8)
    buffer_load_dwordx4 v[244:247], v1, s[32:35], s46 offen offset:1024 nt
    s_cbranch_vccnz L_deep_30
    s_waitcnt vmcnt(4)
L_deep_30:
    s_waitcnt vmcnt(8)
    buffer_load_dwordx4 v[248:251], v1, s[32:35], s46 offen offset:2048 nt
    s_cbranch_vccnz L_deep_31
    s_waitcnt vmcnt(4)
L_deep_31:
    s_waitcnt vmcnt(8)
    buffer_load_dwordx4 v[252:255], v1, s[32:35], s46 offen offset:3072 nt
    s_addk_i32 s46, 16384
    s_bitset0_b32 s46, 17
    s_lshl_b32 s3, s29, 7
    s_add_u32 s3, s3, 823296
    v_and_b32 v32, 31, v0
    v_lshl_add_u32 v32, v32, 2, s3
    global_load_dword v32, v32, s[26:27] sc1
    s_waitcnt vmcnt(8)
    buffer_load_dwordx4 v[72:75], v2, s[36:39], s46 offen offset:0 nt
    s_waitcnt vmcnt(8)
    buffer_load_dwordx4 v[76:79], v2, s[36:39], s46 offen offset:1024 nt
    s_waitcnt vmcnt(8)
    buffer_load_dwordx4 v[80:83], v2, s[36:39], s46 offen offset:2048 nt
    s_waitcnt vmcnt(8)
    buffer_load_dwordx4 v[84:87], v2, s[36:39], s46 offen offset:3072 nt
    s_addk_i32 s46, 16384
    s_bitset0_b32 s46, 17
    s_waitcnt vmcnt(8)
    buffer_load_dwordx4 v[88:91], v2, s[36:39], s46 offen offset:0 nt
    s_waitcnt vmcnt(8)
    buffer_load_dwordx4 v[92:95], v2, s[36:39], s46 offen offset:1024 nt
    s_waitcnt vmcnt(8)
    buffer_load_dwordx4 v[96:99], v2, s[36:39], s46 offen offset:2048 nt
    s_waitcnt vmcnt(8)
    buffer_load_dwordx4 v[100:103], v2, s[36:39], s46 offen offset:3072 nt
    s_addk_i32 s46, 16384
    s_bitset0_b32 s46, 17
    s_waitcnt vmcnt(8)
    buffer_load_dwordx4 v[104:107], v2, s[36:39], s46 offen offset:0 nt
    s_waitcnt vmcnt(8)
    buffer_load_dwordx4 v[108:111], v2, s[36:39], s46 offen offset:1024 nt
    s_mov_b32 s62, 0x400000
L_spin_32:
    ds_read_b32 v3, v7 offset:36
    s_sub_u32 s62, s62, 1
    s_cbranch_scc1 L_spun_33
    s_waitcnt lgkmcnt(0)
    v_readfirstlane_b32 s3, v3
    s_nop 0
    s_cmp_lt_u32 s3, 1
    s_cbranch_scc1 L_spin_32
L_spun_33:
    s_waitcnt lgkmcnt(0)
    ds_read_b128 v[12:15], v60
    s_waitcnt vmcnt(10)
    s_waitcnt lgkmcnt(0)
    s_getreg_b32 s3, hwreg(HW_REG_XCC_ID, 0, 4)
    s_and_b32 s57, s63, -16
    s_or_b32 s57, s57, s3
    v_cmp_ne_u32 vcc, s57, v32
    s_nop 0
    s_or_b32 s59, vcc_lo, vcc_hi
    s_mov_b64 vcc, s[42:43]
    v_cndmask_b32 v8, v12, 0, s[52:53]
    v_cndmask_b32 v9, v13, 0, s[52:53]
    v_cndmask_b32 v10, v14, 0, s[52:53]
    v_cndmask_b32 v11, v15, 0, s[52:53]
    v_cndmask_b32 v12, 0, v12, s[52:53]
    v_cndmask_b32 v13, 0, v13, s[52:53]
    v_cndmask_b32 v14, 0, v14, s[52:53]
    v_cndmask_b32 v15, 0, v15, s[52:53]
    s_waitcnt vmcnt(42)
    v_mfma_f32_16x16x32_bf16 v[16:19], v[128:131], v[8:11], 0
    v_mfma_f32_16x16x32_bf16 v[16:19], v[132:135], v[12:15], v[16:19]
    s_waitcnt vmcnt(39)
    v_mfma_f32_16x16x32_bf16 v[20:23], v[136:139], v[8:11], 0
    v_mfma_f32_16x16x32_bf16 v[20:23], v[140:143], v[12:15], v[20:23]
    s_waitcnt vmcnt(37)
    v_mfma_f32_16x16x32_bf16 v[24:27], v[144:147], v[8:11], 0
    v_mfma_f32_16x16x32_bf16 v[24:27], v[148:151], v[12:15], v[24:27]
    s_waitcnt vmcnt(35)
    v_mfma_f32_16x16x32_bf16 v[28:31], v[152:155], v[8:11], 0
    v_mfma_f32_16x16x32_bf16 v[28:31], v[156:159], v[12:15], v[28:31]
    s_waitcnt vmcnt(8)
    buffer_load_dwordx4 v[128:131], v2, s[36:39], s46 offen offset:2048 nt
    v_mov_b32 v32, v16 quad_perm:[0,0,0,0] row_mask:0xf bank_mask:0xf
    v_add_f32 v32, v17, v32 quad_perm:[1,1,1,1] row_mask:0xf bank_mask:0xf
    v_add_f32 v32, v18, v32 quad_perm:[2,2,2,2] row_mask:0xf bank_mask:0xf
    v_add_f32 v32, v19, v32 quad_perm:[3,3,3,3] row_mask:0xf bank_mask:0xf
    v_mov_b32 v33, v20 quad_perm:[0,0,0,0] row_mask:0xf bank_mask:0xf
    v_add_f32 v33, v21, v33 quad_perm:[1,1,1,1] row_mask:0xf bank_mask:0xf
    v_add_f32 v33, v22, v33 quad_perm:[2,2,2,2] row_mask:0xf bank_mask:0xf
    v_add_f32 v33, v23, v33 quad_perm:[3,3,3,3] row_mask:0xf bank_mask:0xf
    v_mov_b32 v34, v24 quad_perm:[0,0,0,0] row_mask:0xf bank_mask:0xf
    v_add_f32 v34, v25, v34 quad_perm:[1,1,1,1] row_mask:0xf bank_mask:0xf
    v_add_f32 v34, v26, v34 quad_perm:[2,2,2,2] row_mask:0xf bank_mask:0xf
    v_add_f32 v34, v27, v34 quad_perm:[3,3,3,3] row_mask:0xf bank_mask:0xf
    v_mov_b32 v35, v28 quad_perm:[0,0,0,0] row_mask:0xf bank_mask:0xf
    v_add_f32 v35, v29, v35 quad_perm:[1,1,1,1] row_mask:0xf bank_mask:0xf
    v_add_f32 v35, v30, v35 quad_perm:[2,2,2,2] row_mask:0xf bank_mask:0xf
    v_add_f32 v35, v31, v35 quad_perm:[3,3,3,3] row_mask:0xf bank_mask:0xf
    v_cndmask_b32 v32, v32, v33, s[48:49]
    v_cndmask_b32 v34, v34, v35, s[48:49]
    v_cndmask_b32 v40, v32, v34, s[50:51]
    s_waitcnt vmcnt(34)
    v_mfma_f32_16x16x32_bf16 v[16:19], v[160:163], v[8:11], 0
    v_mfma_f32_16x16x32_bf16 v[16:19], v[164:167], v[12:15], v[16:19]
    s_waitcnt vmcnt(32)
    v_mfma_f32_16x16x32_bf16 v[20:23], v[168:171], v[8:11], 0
    v_mfma_f32_16x16x32_bf16 v[20:23], v[172:175], v[12:15], v[20:23]
    s_waitcnt vmcnt(30)
    v_mfma_f32_16x16x32_bf16 v[24:27], v[176:179], v[8:11], 0
    v_mfma_f32_16x16x32_bf16 v[24:27], v[180:183], v[12:15], v[24:27]
    s_waitcnt vmcnt(28)
    v_mfma_f32_16x16x32_bf16 v[28:31], v[184:187], v[8:11], 0
    v_mfma_f32_16x16x32_bf16 v[28:31], v[188:191], v[12:15], v[28:31]
    s_waitcnt vmcnt(8)
    buffer_load_dwordx4 v[132:135], v2, s[36:39], s46 offen offset:3072 nt
    s_addk_i32 s46, 16384
    s_bitset0_b32 s46, 17
    v_mov_b32 v32, v16 quad_perm:[0,0,0,0] row_mask:0xf bank_mask:0xf
    v_add_f32 v32, v17, v32 quad_perm:[1,1,1,1] row_mask:0xf bank_mask:0xf
    v_add_f32 v32, v18, v32 quad_perm:[2,2,2,2] row_mask:0xf bank_mask:0xf
    v_add_f32 v32, v19, v32 quad_perm:[3,3,3,3] row_mask:0xf bank_mask:0xf
    v_mov_b32 v33, v20 quad_perm:[0,0,0,0] row_mask:0xf bank_mask:0xf
    v_add_f32 v33, v21, v33 quad_perm:[1,1,1,1] row_mask:0xf bank_mask:0xf
    v_add_f32 v33, v22, v33 quad_perm:[2,2,2,2] row_mask:0xf bank_mask:0xf
    v_add_f32 v33, v23, v33 quad_perm:[3,3,3,3] row_mask:0xf bank_mask:0xf
    v_mov_b32 v34, v24 quad_perm:[0,0,0,0] row_mask:0xf bank_mask:0xf
    v_add_f32 v34, v25, v34 quad_perm:[1,1,1,1] row_mask:0xf bank_mask:0xf
    v_add_f32 v34, v26, v34 quad_perm:[2,2,2,2] row_mask:0xf bank_mask:0xf
    v_add_f32 v34, v27, v34 quad_perm:[3,3,3,3] row_mask:0xf bank_mask:0xf
    v_mov_b32 v35, v28 quad_perm:[0,0,0,0] row_mask:0xf bank_mask:0xf
    v_add_f32 v35, v29, v35 quad_perm:[1,1,1,1] row_mask:0xf bank_mask:0xf
    v_add_f32 v35, v30, v35 quad_perm:[2,2,2,2] row_mask:0xf bank_mask:0xf
    v_add_f32 v35, v31, v35 quad_perm:[3,3,3,3] row_mask:0xf bank_mask:0xf
    v_cndmask_b32 v32, v32, v33, s[48:49]
    v_cndmask_b32 v34, v34, v35, s[48:49]
    v_cndmask_b32 v41, v32, v34, s[50:51]
    s_waitcnt vmcnt(27)
    v_mfma_f32_16x16x32_bf16 v[16:19], v[192:195], v[8:11], 0
    v_mfma_f32_16x16x32_bf16 v[16:19], v[196:199], v[12:15], v[16:19]
    s_waitcnt vmcnt(25)
    v_mfma_f32_16x16x32_bf16 v[20:23], v[200:203], v[8:11], 0
    v_mfma_f32_16x16x32_bf16 v[20:23], v[204:207], v[12:15], v[20:23]
    s_waitcnt vmcnt(23)
    v_mfma_f32_16x16x32_bf16 v[24:27], v[208:211], v[8:11], 0
    v_mfma_f32_16x16x32_bf16 v[24:27], v[212:215], v[12:15], v[24:27]
    s_waitcnt vmcnt(21)
    v_mfma_f32_16x16x32_bf16 v[28:31], v[216:219], v[8:11], 0
    v_mfma_f32_16x16x32_bf16 v[28:31], v[220:223], v[12:15], v[28:31]
    s_waitcnt vmcnt(8)
    buffer_load_dwordx4 v[136:139], v2, s[36:39], s46 offen offset:0 nt
    v_mov_b32 v32, v16 quad_perm:[0,0,0,0] row_mask:0xf bank_mask:0xf
    v_add_f32 v32, v17, v32 quad_perm:[1,1,1,1] row_mask:0xf bank_mask:0xf
    v_add_f32 v32, v18, v32 quad_perm:[2,2,2,2] row_mask:0xf bank_mask:0xf
    v_add_f32 v32, v19, v32 quad_perm:[3,3,3,3] row_mask:0xf bank_mask:0xf
    v_mov_b32 v33, v20 quad_perm:[0,0,0,0] row_mask:0xf bank_mask:0xf
    v_add_f32 v33, v21, v33 quad_perm:[1,1,1,1] row_mask:0xf bank_mask:0xf
    v_add_f32 v33, v22, v33 quad_perm:[2,2,2,2] row_mask:0xf bank_mask:0xf
    v_add_f32 v33, v23, v33 quad_perm:[3,3,3,3] row_mask:0xf bank_mask:0xf
    v_mov_b32 v34, v24 quad_perm:[0,0,0,0] row_mask:0xf bank_mask:0xf
    v_add_f32 v34, v25, v34 quad_perm:[1,1,1,1] row_mask:0xf bank_mask:0xf
    v_add_f32 v34, v26, v34 quad_perm:[2,2,2,2] row_mask:0xf bank_mask:0xf
    v_add_f32 v34, v27, v34 quad_perm:[3,3,3,3] row_mask:0xf bank_mask:0xf
    v_mov_b32 v35, v28 quad_perm:[0,0,0,0] row_mask:0xf bank_mask:0xf
    v_add_f32 v35, v29, v35 quad_perm:[1,1,1,1] row_mask:0xf bank_mask:0xf
    v_add_f32 v35, v30, v35 quad_perm:[2,2,2,2] row_mask:0xf bank_mask:0xf
    v_add_f32 v35, v31, v35 quad_perm:[3,3,3,3] row_mask:0xf bank_mask:0xf
    v_cndmask_b32 v32, v32, v33, s[48:49]
    v_cndmask_b32 v34, v34, v35, s[48:49]
    v_cndmask_b32 v42, v32, v34, s[50:51]
    s_waitcnt vmcnt(20)
    v_mfma_f32_16x16x32_bf16 v[16:19], v[224:227], v[8:11], 0
    v_mfma_f32_16x16x32_bf16 v[16:19], v[228:231], v[12:15], v[16:19]
    s_waitcnt vmcnt(18)
    v_mfma_f32_16x16x32_bf16 v[20:23], v[232:235], v[8:11], 0
    v_mfma_f32_16x16x32_bf16 v[20:23], v[236:239], v[12:15], v[20:23]
    s_waitcnt vmcnt(16)
    v_mfma_f32_16x16x32_bf16 v[24:27], v[240:243], v[8:11], 0
    v_mfma_f32_16x16x32_bf16 v[24:27], v[244:247], v[12:15], v[24:27]
    s_waitcnt vmcnt(14)
    v_mfma_f32_16x16x32_bf16 v[28:31], v[248:251], v[8:11], 0
    v_mfma_f32_16x16x32_bf16 v[28:31], v[252:255], v[12:15], v[28:31]
    s_waitcnt vmcnt(8)
    buffer_load_dwordx4 v[140:143], v2, s[36:39], s46 offen offset:1024 nt
    v_mov_b32 v32, v16 quad_perm:[0,0,0,0] row_mask:0xf bank_mask:0xf
    v_add_f32 v32, v17, v32 quad_perm:[1,1,1,1] row_mask:0xf bank_mask:0xf
    v_add_f32 v32, v18, v32 quad_perm:[2,2,2,2] row_mask:0xf bank_mask:0xf
    v_add_f32 v32, v19, v32 quad_perm:[3,3,3,3] row_mask:0xf bank_mask:0xf
    v_mov_b32 v33, v20 quad_perm:[0,0,0,0] row_mask:0xf bank_mask:0xf
    v_add_f32 v33, v21, v33 quad_perm:[1,1,1,1] row_mask:0xf bank_mask:0xf
    v_add_f32 v33, v22, v33 quad_perm:[2,2,2,2] row_mask:0xf bank_mask:0xf
    v_add_f32 v33, v23, v33 quad_perm:[3,3,3,3] row_mask:0xf bank_mask:0xf
    v_mov_b32 v34, v24 quad_perm:[0,0,0,0] row_mask:0xf bank_mask:0xf
    v_add_f32 v34, v25, v34 quad_perm:[1,1,1,1] row_mask:0xf bank_mask:0xf
    v_add_f32 v34, v26, v34 quad_perm:[2,2,2,2] row_mask:0xf bank_mask:0xf
    v_add_f32 v34, v27, v34 quad_perm:[3,3,3,3] row_mask:0xf bank_mask:0xf
    v_mov_b32 v35, v28 quad_perm:[0,0,0,0] row_mask:0xf bank_mask:0xf
    v_add_f32 v35, v29, v35 quad_perm:[1,1,1,1] row_mask:0xf bank_mask:0xf
    v_add_f32 v35, v30, v35 quad_perm:[2,2,2,2] row_mask:0xf bank_mask:0xf
    v_add_f32 v35, v31, v35 quad_perm:[3,3,3,3] row_mask:0xf bank_mask:0xf
    v_cndmask_b32 v32, v32, v33, s[48:49]
    v_cndmask_b32 v34, v34, v35, s[48:49]
    v_cndmask_b32 v43, v32, v34, s[50:51]
    s_waitcnt vmcnt(8)
    buffer_load_dwordx4 v[144:147], v2, s[36:39], s46 offen offset:2048 nt
    s_mov_b32 s54, 0x3db504f3
    s_mov_b32 s55, 0x3fb8aa3b
    v_cvt_pk_bf16_f32 v3, v40, v41
    v_cvt_pk_bf16_f32 v4, v42, v43
    v_lshlrev_b32 v40, 16, v3
    v_and_b32 v41, 0xffff0000, v3
    v_lshlrev_b32 v42, 16, v4
    v_and_b32 v43, 0xffff0000, v4
    v_mul_f32 v40, s54, v40
    v_mul_f32 v41, s54, v41
    v_mul_f32 v42, s54, v42
    v_mul_f32 v43, s54, v43
    v_cvt_pk_bf16_f32 v3, v40, v41
    v_cvt_pk_bf16_f32 v4, v42, v43
    v_lshlrev_b32 v40, 16, v3
    v_and_b32 v41, 0xffff0000, v3
    v_lshlrev_b32 v42, 16, v4
    v_and_b32 v43, 0xffff0000, v4
    v_max3_f32 v66, v40, v41, v42
    v_max_f32 v66, v66, v43
    s_nop 1
    v_max_f32 v66, v66, v66 quad_perm:[1,0,3,2] row_mask:0xf bank_mask:0xf
    s_nop 1
    v_max_f32 v66, v66, v66 quad_perm:[2,3,0,1] row_mask:0xf bank_mask:0xf
    s_nop 1
    v_max_f32 v66, v66, v66 row_half_mirror row_mask:0xf bank_mask:0xf
    v_mov_b32 v3, v66
    s_nop 1
    v_permlane16_swap_b32 v66, v3
    v_max_f32 v66, v66, v3
    v_mov_b32 v3, v66
    s_nop 1
    v_permlane32_swap_b32 v66, v3
    v_max_f32 v66, v66, v3
    s_waitcnt vmcnt(8)
    buffer_load_dwordx4 v[148:151], v2, s[36:39], s46 offen offset:3072 nt
    s_addk_i32 s46, 16384
    s_bitset0_b32 s46, 17
    v_sub_f32 v40, v40, v66
    v_sub_f32 v41, v41, v66
    v_sub_f32 v42, v42, v66
    v_sub_f32 v43, v43, v66
    v_mul_f32 v40, s55, v40
    v_mul_f32 v41, s55, v41
    v_mul_f32 v42, s55, v42
    v_mul_f32 v43, s55, v43
    v_exp_f32 v40, v40
    v_exp_f32 v41, v41
    v_exp_f32 v42, v42
    v_exp_f32 v43, v43
    v_cvt_pk_bf16_f32 v32, v40, v40
    v_cvt_pk_bf16_f32 v33, v41, v41
    v_cvt_pk_bf16_f32 v34, v42, v42
    v_cvt_pk_bf16_f32 v35, v43, v43
    ds_write_b32 v61, v32 offset:0
    ds_write_b32 v61, v33 offset:32
    ds_write_b32 v61, v34 offset:64
    ds_write_b32 v61, v35 offset:96
    ds_read_b128 v[8:11], v62 offset:0
    ds_read_b128 v[12:15], v62 offset:16
    ds_read_b128 v[16:19], v62 offset:32
    ds_read_b128 v[20:23], v62 offset:48
    ds_read_b128 v[24:27], v62 offset:64
    ds_read_b128 v[28:31], v62 offset:80
    ds_read_b128 v[32:35], v62 offset:96
    ds_read_b128 v[36:39], v62 offset:112
    v_add_f32 v67, v40, v41
    v_add_f32 v3, v42, v43
    v_add_f32 v67, v67, v3
    s_nop 1
    v_add_f32 v67, v67, v67 quad_perm:[1,0,3,2] row_mask:0xf bank_mask:0xf
    s_nop 1
    v_add_f32 v67, v67, v67 quad_perm:[2,3,0,1] row_mask:0xf bank_mask:0xf
    s_nop 1
    v_add_f32 v67, v67, v67 row_half_mirror row_mask:0xf bank_mask:0xf
    v_mov_b32 v3, v67
    s_nop 1
    v_permlane16_swap_b32 v67, v3
    v_add_f32 v67, v67, v3
    v_mov_b32 v3, v67
    s_nop 1
    v_permlane32_swap_b32 v67, v3
    v_add_f32 v67, v67, v3
    s_mov_b64 exec, 0x101
    ds_write_b64 v63, v[66:67]
    s_mov_b64 exec, 1
    ds_add_u32 v7, v6 offset:4
    s_mov_b64 exec, -1
    s_waitcnt vmcnt(8)
    buffer_load_dwordx4 v[152:155], v2, s[36:39], s46 offen offset:0 nt
    s_waitcnt lgkmcnt(0)
    v_and_b32 v48, v8, v44
    v_and_b32 v49, v8, v45
    v_and_b32 v50, v8, v46
    v_and_b32 v51, v8, v47
    v_and_b32 v52, v9, v44
    v_and_b32 v53, v9, v45
    v_and_b32 v54, v9, v46
    v_and_b32 v55, v9, v47
    s_waitcnt vmcnt(16)
    v_mfma_f32_16x16x32_bf16 v[56:59], v[72:75], v[48:51], 0
    s_waitcnt vmcnt(8)
    buffer_load_dwordx4 v[156:159], v2, s[36:39], s46 offen offset:1024 nt
    v_and_b32 v48, v10, v44
    v_and_b32 v49, v10, v45
    v_and_b32 v50, v10, v46
    v_and_b32 v51, v10, v47
    s_waitcnt vmcnt(16)
    v_mfma_f32_16x16x32_bf16 v[56:59], v[76:79], v[52:55], v[56:59]
    v_and_b32 v52, v11, v44
    v_and_b32 v53, v11, v45
    v_and_b32 v54, v11, v46
    v_and_b32 v55, v11, v47
    s_waitcnt vmcnt(15)
    v_mfma_f32_16x16x32_bf16 v[56:59], v[80:83], v[48:51], v[56:59]
    s_waitcnt vmcnt(8)
    buffer_load_dwordx4 v[160:163], v2, s[36:39], s46 offen offset:2048 nt
    v_and_b32 v48, v12, v44
    v_and_b32 v49, v12, v45
    v_and_b32 v50, v12, v46
    v_and_b32 v51, v12, v47
    s_waitcnt vmcnt(15)
    v_mfma_f32_16x16x32_bf16 v[56:59], v[84:87], v[52:55], v[56:59]
    v_and_b32 v52, v13, v44
    v_and_b32 v53, v13, v45
    v_and_b32 v54, v13, v46
    v_and_b32 v55, v13, v47
    s_waitcnt vmcnt(14)
    v_mfma_f32_16x16x32_bf16 v[56:59], v[88:91], v[48:51], v[56:59]
    s_waitcnt vmcnt(8)
    buffer_load_dwordx4 v[164:167], v2, s[36:39], s46 offen offset:3072 nt
    s_addk_i32 s46, 16384
    s_bitset0_b32 s46, 17
    v_and_b32 v48, v14, v44
    v_and_b32 v49, v14, v45
    v_and_b32 v50, v14, v46
    v_and_b32 v51, v14, v47
    s_waitcnt vmcnt(14)
    v_mfma_f32_16x16x32_bf16 v[56:59], v[92:95], v[52:55], v[56:59]
    v_and_b32 v52, v15, v44
    v_and_b32 v53, v15, v45
    v_and_b32 v54, v15, v46
    v_and_b32 v55, v15, v47
    s_waitcnt vmcnt(13)
    v_mfma_f32_16x16x32_bf16 v[56:59], v[96:99], v[48:51], v[56:59]
    s_waitcnt vmcnt(8)
    buffer_load_dwordx4 v[168:171], v2, s[36:39], s46 offen offset:0 nt
    v_and_b32 v48, v16, v44
    v_and_b32 v49, v16, v45
    v_and_b32 v50, v16, v46
    v_and_b32 v51, v16, v47
    s_waitcnt vmcnt(13)
    v_mfma_f32_16x16x32_bf16 v[56:59], v[100:103], v[52:55], v[56:59]
    v_and_b32 v52, v17, v44
    v_and_b32 v53, v17, v45
    v_and_b32 v54, v17, v46
    v_and_b32 v55, v17, v47
    s_waitcnt vmcnt(12)
    v_mfma_f32_16x16x32_bf16 v[56:59], v[104:107], v[48:51], v[56:59]
    s_waitcnt vmcnt(8)
    buffer_load_dwordx4 v[172:175], v2, s[36:39], s46 offen offset:1024 nt
    v_and_b32 v48, v18, v44
    v_and_b32 v49, v18, v45
    v_and_b32 v50, v18, v46
    v_and_b32 v51, v18, v47
    s_waitcnt vmcnt(12)
    v_mfma_f32_16x16x32_bf16 v[56:59], v[108:111], v[52:55], v[56:59]
    v_and_b32 v52, v19, v44
    v_and_b32 v53, v19, v45
    v_and_b32 v54, v19, v46
    v_and_b32 v55, v19, v47
    s_waitcnt vmcnt(11)
    v_mfma_f32_16x16x32_bf16 v[56:59], v[128:131], v[48:51], v[56:59]
    s_waitcnt vmcnt(8)
    buffer_load_dwordx4 v[176:179], v2, s[36:39], s46 offen offset:2048 nt
    v_and_b32 v48, v20, v44
    v_and_b32 v49, v20, v45
    v_and_b32 v50, v20, v46
    v_and_b32 v51, v20, v47
    s_waitcnt vmcnt(11)
    v_mfma_f32_16x16x32_bf16 v[56:59], v[132:135], v[52:55], v[56:59]
    s_mov_b32 s62, 0x400000
L_spin_34:
    ds_read_b32 v3, v7 offset:4
    s_sub_u32 s62, s62, 1
    s_cbranch_scc1 L_spun_35
    s_waitcnt lgkmcnt(0)
    v_readfirstlane_b32 s3, v3
    s_nop 0
    s_cmp_lt_u32 s3, 4
    s_cbranch_scc1 L_spin_34
L_spun_35:
    s_waitcnt lgkmcnt(0)
    ds_read_b64 v[40:41], v64
    s_waitcnt lgkmcnt(0)
    v_max_f32 v68, v40, v40 quad_perm:[1,0,3,2] row_mask:0xf bank_mask:0xf
    s_nop 1
    v_max_f32 v68, v68, v68 quad_perm:[2,3,0,1] row_mask:0xf bank_mask:0xf
    v_sub_f32 v40, v40, v68
    v_sub_f32 v5, v66, v68
    v_mul_f32 v40, s55, v40
    v_mul_f32 v5, s55, v5
    v_exp_f32 v40, v40
    v_exp_f32 v5, v5
    v_mul_f32 v40, v40, v41
    s_nop 1
    v_add_f32 v40, v40, v40 quad_perm:[1,0,3,2] row_mask:0xf bank_mask:0xf
    s_nop 1
    v_add_f32 v70, v40, v40 quad_perm:[2,3,0,1] row_mask:0xf bank_mask:0xf
    v_rcp_f32 v3, v70
    v_and_b32 v4, 8, v0
    v_mul_f32 v5, v5, v3
    s_lshl_b32 s3, s47, 5
    s_add_u32 s3, s3, 786432
    v_lshl_add_u32 v4, v4, 1, s3
    s_cmpk_lg_u32 s28, 256
    s_cbranch_scc1 L_A_nost
    s_mov_b64 exec, 0x101
    s_cmp_eq_u32 s59, 0
    s_cbranch_scc0 L_far_36
    global_store_dwordx4 v4, v[68:71], s[26:27]
    s_branch L_st_37
L_far_36:
    global_store_dwordx4 v4, v[68:71], s[26:27] sc1
L_st_37:
    s_mov_b64 exec, -1
L_A_nost:
    v_and_b32 v52, v21, v44
    v_and_b32 v53, v21, v45
    v_and_b32 v54, v21, v46
    v_and_b32 v55, v21, v47
    s_waitcnt vmcnt(10)
    v_mfma_f32_16x16x32_bf16 v[56:59], v[136:139], v[48:51], v[56:59]
    s_waitcnt vmcnt(8)
    buffer_load_dwordx4 v[180:183], v2, s[36:39], s46 offen offset:3072 nt
    s_addk_i32 s46, 16384
    s_bitset0_b32 s46, 17
    v_and_b32 v48, v22, v44
    v_and_b32 v49, v22, v45
    v_and_b32 v50, v22, v46
    v_and_b32 v51, v22, v47
    s_waitcnt vmcnt(10)
    v_mfma_f32_16x16x32_bf16 v[56:59], v[140:143], v[52:55], v[56:59]
    s_waitcnt vmcnt(8)
    buffer_load_dwordx4 v[184:187], v2, s[36:39], s46 offen offset:0 nt
    v_and_b32 v52, v23, v44
    v_and_b32 v53, v23, v45
    v_and_b32 v54, v23, v46
    v_and_b32 v55, v23, v47
    s_waitcnt vmcnt(10)
    v_mfma_f32_16x16x32_bf16 v[56:59], v[144:147], v[48:51], v[56:59]
    s_waitcnt vmcnt(8)
    buffer_load_dwordx4 v[188:191], v2, s[36:39], s46 offen offset:1024 nt
    v_and_b32 v48, v24, v44
    v_and_b32 v49, v24, v45
    v_and_b32 v50, v24, v46
    v_and_b32 v51, v24, v47
    s_waitcnt vmcnt(10)
    v_mfma_f32_16x16x32_bf16 v[56:59], v[148:151], v[52:55], v[56:59]
    s_waitcnt vmcnt(8)
    buffer_load_dwordx4 v[192:195], v2, s[36:39], s46 offen offset:2048 nt
    v_and_b32 v52, v25, v44
    v_and_b32 v53, v25, v45
    v_and_b32 v54, v25, v46
    v_and_b32 v55, v25, v47
    s_waitcnt vmcnt(10)
    v_mfma_f32_16x16x32_bf16 v[56:59], v[152:155], v[48:51], v[56:59]
    s_waitcnt vmcnt(8)
    buffer_load_dwordx4 v[196:199], v2, s[36:39], s46 offen offset:3072 nt
    s_addk_i32 s46, 16384
    s_bitset0_b32 s46, 17
    v_and_b32 v48, v26, v44
    v_and_b32 v49, v26, v45
    v_and_b32 v50, v26, v46
    v_and_b32 v51, v26, v47
    s_waitcnt vmcnt(10)
    v_mfma_f32_16x16x32_bf16 v[56:59], v[156:159], v[52:55], v[56:59]
    s_waitcnt vmcnt(8)
    buffer_load_dwordx4 v[200:203], v2, s[36:39], s46 offen offset:0 nt
    v_and_b32 v52, v27, v44
    v_and_b32 v53, v27, v45
    v_and_b32 v54, v27, v46
    v_and_b32 v55, v27, v47
    s_waitcnt vmcnt(10)
    v_mfma_f32_16x16x32_bf16 v[56:59], v[160:163], v[48:51], v[56:59]
    s_waitcnt vmcnt(8)
    buffer_load_dwordx4 v[204:207], v2, s[36:39], s46 offen offset:1024 nt
    v_and_b32 v48, v28, v44
    v_and_b32 v49, v28, v45
    v_and_b32 v50, v28, v46
    v_and_b32 v51, v28, v47
    s_waitcnt vmcnt(10)
    v_mfma_f32_16x16x32_bf16 v[56:59], v[164:167], v[52:55], v[56:59]
    s_waitcnt vmcnt(8)
    buffer_load_dwordx4 v[208:211], v2, s[36:39], s46 offen offset:2048 nt
    v_and_b32 v52, v29, v44
    v_and_b32 v53, v29, v45
    v_and_b32 v54, v29, v46
    v_and_b32 v55, v29, v47
    s_waitcnt vmcnt(10)
    v_mfma_f32_16x16x32_bf16 v[56:59], v[168:171], v[48:51], v[56:59]
    s_waitcnt vmcnt(8)
    buffer_load_dwordx4 v[212:215], v2, s[36:39], s46 offen offset:3072 nt
    s_addk_i32 s46, 16384
    s_bitset0_b32 s46, 17
    s_mov_b64 exec, 1
    ds_add_u32 v7, v6 offset:8
    s_mov_b64 exec, -1
    v_and_b32 v48, v30, v44
    v_and_b32 v49, v30, v45
    v_and_b32 v50, v30, v46
    v_and_b32 v51, v30, v47
    s_waitcnt vmcnt(10)
    v_mfma_f32_16x16x32_bf16 v[56:59], v[172:175], v[52:55], v[56:59]
    v_and_b32 v52, v31, v44
    v_and_b32 v53, v31, v45
    v_and_b32 v54, v31, v46
    v_and_b32 v55, v31, v47
    s_waitcnt vmcnt(9)
    v_mfma_f32_16x16x32_bf16 v[56:59], v[176:179], v[48:51], v[56:59]
    v_and_b32 v48, v32, v44
    v_and_b32 v49, v32, v45
    v_and_b32 v50, v32, v46
    v_and_b32 v51, v32, v47
    s_waitcnt vmcnt(8)
    v_mfma_f32_16x16x32_bf16 v[56:59], v[180:183], v[52:55], v[56:59]
    v_and_b32 v52, v33, v44
    v_and_b32 v53, v33, v45
    v_and_b32 v54, v33, v46
    v_and_b32 v55, v33, v47
    s_waitcnt vmcnt(7)
    v_mfma_f32_16x16x32_bf16 v[56:59], v[184:187], v[48:51], v[56:59]
    v_and_b32 v48, v34, v44
    v_and_b32 v49, v34, v45
    v_and_b32 v50, v34, v46
    v_and_b32 v51, v34, v47
    s_waitcnt vmcnt(6)
    v_mfma_f32_16x16x32_bf16 v[56:59], v[188:191], v[52:55], v[56:59]
    v_and_b32 v4, 63, v0
    v_lshlrev_b32 v60, 4, v4
    v_add_u32 v60, 129536, v60
    s_lshl_b32 s3, s47, 10
    s_add_u32 s3, s3, 524288
    v_lshl_add_u32 v4, v4, 4, s3
    v_and_b32 v52, v35, v44
    v_and_b32 v53, v35, v45
    v_and_b32 v54, v35, v46
    v_and_b32 v55, v35, v47
    s_waitcnt vmcnt(5)
    v_mfma_f32_16x16x32_bf16 v[56:59], v[192:195], v[48:51], v[56:59]
    v_and_b32 v48, v36, v44
    v_and_b32 v49, v36, v45
    v_and_b32 v50, v36, v46
    v_and_b32 v51, v36, v47
    s_waitcnt vmcnt(4)
    v_mfma_f32_16x16x32_bf16 v[56:59], v[196:199], v[52:55], v[56:59]
    v_and_b32 v52, v37, v44
    v_and_b32 v53, v37, v45
    v_and_b32 v54, v37, v46
    v_and_b32 v55, v37, v47
    s_waitcnt vmcnt(3)
    v_mfma_f32_16x16x32_bf16 v[56:59], v[200:203], v[48:51], v[56:59]
    v_and_b32 v48, v38, v44
    v_and_b32 v49, v38, v45
    v_and_b32 v50, v38, v46
    v_and_b32 v51, v38, v47
    s_waitcnt vmcnt(2)
    v_mfma_f32_16x16x32_bf16 v[56:59], v[204:207], v[52:55], v[56:59]
    v_and_b32 v52, v39, v44
    v_and_b32 v53, v39, v45
    v_and_b32 v54, v39, v46
    v_and_b32 v55, v39, v47
    s_waitcnt vmcnt(1)
    v_mfma_f32_16x16x32_bf16 v[56:59], v[208:211], v[48:51], v[56:59]
    s_waitcnt vmcnt(0)
    v_mfma_f32_16x16x32_bf16 v[56:59], v[212:215], v[52:55], v[56:59]
    s_nop 7
    v_mul_f32 v56, v5, v56
    v_mul_f32 v57, v5, v57
    v_mul_f32 v58, v5, v58
    v_mul_f32 v59, v5, v59
    ds_write_b128 v65, v[56:59]
    s_mov_b64 exec, 1
    ds_add_rtn_u32 v3, v7, v6 offset:16
    s_mov_b64 exec, -1
    ds_read_b128 v[8:11], v60
    ds_read_b128 v[12:15], v60 offset:1024
    ds_read_b128 v[16:19], v60 offset:2048
    ds_read_b128 v[20:23], v60 offset:3072
    s_waitcnt lgkmcnt(4)
    v_readfirstlane_b32 s3, v3
    s_nop 0
    s_cmp_lg_u32 s3, 3
    s_cbranch_scc1 L_A_done
    s_waitcnt lgkmcnt(2)
    v_pk_add_f32 v[8:9], v[8:9], v[12:13]
    v_pk_add_f32 v[10:11], v[10:11], v[14:15]
    s_waitcnt lgkmcnt(0)
    v_pk_add_f32 v[16:17], v[16:17], v[20:21]
    v_pk_add_f32 v[18:19], v[18:19], v[22:23]
    v_pk_add_f32 v[8:9], v[8:9], v[16:17]
    v_pk_add_f32 v[10:11], v[10:11], v[18:19]
    v_cvt_pk_bf16_f32 v68, v8, v9
    v_cvt_pk_bf16_f32 v70, v10, v11
    s_cmp_eq_u32 s59, 0
    s_cbranch_scc0 L_far_38
    global_store_dwordx4 v4, v[68:71], s[26:27]
    s_branch L_st_39
L_far_38:
    global_store_dwordx4 v4, v[68:71], s[26:27] sc1
L_st_39:
    s_mov_b64 exec, 1
    ds_add_u32 v7, v6 offset:40
    s_mov_b64 exec, -1
L_A_done:
    s_endpgm
.p2align 8
L_W:
    v_and_b32 v1, 63, v0
    v_mov_b32 v64, 133696
    v_mov_b32 v2, 0
    v_lshl_add_u32 v3, v1, 2, v64
    ds_write_b32 v3, v2
    v_lshrrev_b32 v4, 3, v0
    v_and_b32 v5, 2, v4
    v_lshrrev_b32 v6, 4, v0
    v_and_or_b32 v5, v6, 4, v5
    v_and_b32 v6, 7, v0
    v_xor_b32 v5, v5, v6
    v_lshlrev_b32 v5, 4, v5
    s_movk_i32 s3, 0x480
    v_mad_u32_u24 v66, v4, s3, v5
    v_lshrrev_b32 v7, 5, v0
    v_and_b32 v6, 31, v0
    v_mul_u32_u24 v7, s3, v7
    v_lshl_add_u32 v67, v6, 4, v7
    v_lshl_add_u32 v68, v6, 2, v7
    s_mov_b32 s35, 0x20000
    s_cmp_ge_u32 s30, 26
    s_cbranch_scc1 L_O
    s_mul_i32 s41, s30, 43
    s_lshr_b32 s41, s41, 8
    s_mul_i32 s3, s41, 6
    s_sub_u32 s40, s30, s3
    s_cmp_lt_u32 s30, 18
    s_cbranch_scc1 L_P_dec
    s_sub_u32 s41, s30, 17
    s_mul_i32 s41, s41, 86
    s_lshr_b32 s41, s41, 8
    s_mul_i32 s3, s41, 3
    s_sub_u32 s3, s3, 1
    s_max_i32 s3, s3, 0
    s_sub_u32 s40, s30, s3
    s_sub_u32 s40, s40, 12
L_P_dec:
    s_sub_u32 s3, 3, s29
    s_and_b32 s3, s3, 7
    s_add_u32 s42, s40, s3
    s_add_u32 s42, s42, 1
    s_cmp_ge_u32 s42, 9
    s_cselect_b32 s3, 9, 0
    s_sub_u32 s42, s42, s3
    s_mul_i32 s43, s29, 9
    s_add_u32 s43, s43, s42
    s_mul_i32 s44, s41, 72
    s_add_u32 s44, s44, s43
    s_sub_u32 s44, s44, 8
    s_movk_i32 s45, 0x2400
    s_add_u32 s3, s40, 4
    s_and_b32 s3, s3, 7
    s_lshl3_add_u32 s3, s29, s3
    s_cmp_eq_u32 s41, 0
    s_cselect_b32 s43, s3, s43
    s_cselect_b32 s44, s3, s44
    s_cselect_b32 s45, 0x2000, s45
    v_mad_u32_u24 v65, v4, s45, v5
    s_lshl_b32 s43, s43, 7
    s_mul_i32 s34, s45, 576
    s_sub_u32 s34, s34, s43
    s_lshl_b32 s53, s45, 5
    s_waitcnt lgkmcnt(0)
    s_load_dword s63, s[26:27], 819200
    s_cmp_eq_u32 s41, 2
    s_cselect_b32 s32, s18, s16
    s_cselect_b32 s33, s19, s17
    s_cmp_eq_u32 s41, 0
    s_cselect_b32 s32, s10, s32
    s_cselect_b32 s33, s11, s33
    s_add_u32 s32, s32, s43
    s_addc_u32 s33, s33, 0
    s_mov_b32 s54, 0
    s_lshl_b32 s55, s28, 4
    s_add_u32 s56, s55, 28672
L_dma_40:
    s_mov_b32 m0, s55
    s_add_u32 s55, s55, 4096
    buffer_load_dwordx4 v65, s[32:35], s54 offen nt lds
    s_add_u32 s54, s54, s53
L_dmd_41:
    s_cmp_lt_u32 s55, s56
    s_cbranch_scc1 L_dma_40
    s_waitcnt lgkmcnt(0)
    s_barrier
    s_mul_i32 s63, s63, 0x9e3779b1
    s_add_u32 s63, s63, 0x7f4a7c15
    s_getreg_b32 s3, hwreg(HW_REG_XCC_ID, 0, 4)
    s_and_b32 s57, s63, -16
    s_or_b32 s57, s57, s3
    s_cmp_lg_u32 s28, 0
    s_cbranch_scc1 L_nocP
    s_lshl_b32 s3, s29, 5
    s_add_u32 s3, s3, s30
    s_lshl_b32 s3, s3, 2
    s_add_u32 s3, s3, 823296
    v_mov_b32 v3, s3
    v_mov_b32 v2, s57
    s_mov_b64 exec, 1
    global_store_dword v3, v2, s[26:27]
    s_mov_b64 exec, -1
L_nocP:
    s_add_u32 s56, s55, 4096
L_dma_42:
    s_mov_b32 m0, s55
    s_add_u32 s55, s55, 4096
    buffer_load_dwordx4 v65, s[32:35], s54 offen nt lds
    s_add_u32 s54, s54, s53
L_dmd_43:
    s_cmp_lt_u32 s55, s56
    s_cbranch_scc1 L_dma_42
    global_load_dwordx4 v[72:75], v67, s[4:5]
    global_load_dwordx4 v[76:79], v67, s[4:5] offset:512
    global_load_dword v80, v68, s[4:5] offset:1024
    s_add_u32 s56, s55, 40960
L_dma_44:
    s_mov_b32 m0, s55
    s_add_u32 s55, s55, 4096
    buffer_load_dwordx4 v65, s[32:35], s54 offen nt lds
    s_add_u32 s54, s54, s53
L_dmd_45:
    s_cmp_lt_u32 s55, s56
    s_cbranch_scc1 L_dma_44
    s_lshl_b32 s3, s29, 7
    s_add_u32 s3, s3, 823296
    v_and_b32 v81, 31, v0
    v_lshl_add_u32 v81, v81, 2, s3
    global_load_dword v81, v81, s[26:27] sc1
    v_mov_b32 v69, 1
    s_mov_b64 exec, 1
    ds_add_u32 v64, v69 offset:28
    s_mov_b64 exec, -1
    s_mov_b32 s60, 0x00ff00ff
    s_mov_b32 s61, s60
    v_mov_b32 v93, s63
    v_mov_b32 v95, s63
    s_waitcnt vmcnt(11)
    v_lshlrev_b32 v8, 16, v72
    v_and_b32 v9, 0xffff0000, v72
    v_lshlrev_b32 v10, 16, v73
    v_and_b32 v11, 0xffff0000, v73
    v_lshlrev_b32 v12, 16, v74
    v_and_b32 v13, 0xffff0000, v74
    v_lshlrev_b32 v14, 16, v75
    v_and_b32 v15, 0xffff0000, v75
    v_lshlrev_b32 v16, 16, v76
    v_and_b32 v17, 0xffff0000, v76
    v_lshlrev_b32 v18, 16, v77
    v_and_b32 v19, 0xffff0000, v77
    v_lshlrev_b32 v20, 16, v78
    v_and_b32 v21, 0xffff0000, v78
    v_lshlrev_b32 v22, 16, v79
    v_and_b32 v23, 0xffff0000, v79
    v_lshlrev_b32 v24, 16, v80
    v_and_b32 v25, 0xffff0000, v80
    s_mov_b32 s54, 0x3ae38e39
    s_mov_b32 s55, 0x44100000
    v_pk_add_f32 v[26:27], v[8:9], v[10:11]
    v_pk_add_f32 v[26:27], v[26:27], v[12:13]
    v_pk_add_f32 v[26:27], v[26:27], v[14:15]
    v_pk_add_f32 v[26:27], v[26:27], v[16:17]
    v_pk_add_f32 v[26:27], v[26:27], v[18:19]
    v_pk_add_f32 v[26:27], v[26:27], v[20:21]
    v_pk_add_f32 v[26:27], v[26:27], v[22:23]
    v_pk_add_f32 v[26:27], v[26:27], v[24:25]
    v_add_f32 v26, v26, v27
    s_nop 1
    v_add_f32 v26, v26, v26 quad_perm:[1,0,3,2] row_mask:0xf bank_mask:0xf
    s_nop 1
    v_add_f32 v26, v26, v26 quad_perm:[2,3,0,1] row_mask:0xf bank_mask:0xf
    s_nop 1
    v_add_f32 v26, v26, v26 row_half_mirror row_mask:0xf bank_mask:0xf
    s_nop 1
    v_add_f32 v26, v26, v26 row_mirror row_mask:0xf bank_mask:0xf
    v_mov_b32 v3, v26
    s_nop 1
    v_permlane16_swap_b32 v26, v3
    v_add_f32 v26, v26, v3
    v_mul_f32 v3, s54, v26
    v_fma_f32 v26, -v3, s55, v26
    v_fma_f32 v26, v26, s54, v3
    v_mov_b32 v27, 0
    v_mov_b32 v28, 0
    v_sub_f32 v30, v8, v26
    v_fmac_f32 v27, v30, v30
    v_sub_f32 v31, v9, v26
    v_fmac_f32 v28, v31, v31
    v_sub_f32 v32, v10, v26
    v_fmac_f32 v27, v32, v32
    v_sub_f32 v33, v11, v26
    v_fmac_f32 v28, v33, v33
    v_sub_f32 v30, v12, v26
    v_fmac_f32 v27, v30, v30
    v_sub_f32 v31, v13, v26
    v_fmac_f32 v28, v31, v31
    v_sub_f32 v32, v14, v26
    v_fmac_f32 v27, v32, v32
    v_sub_f32 v33, v15, v26
    v_fmac_f32 v28, v33, v33
    v_sub_f32 v30, v16, v26
    v_fmac_f32 v27, v30, v30
    v_sub_f32 v31, v17, v26
    v_fmac_f32 v28, v31, v31
    v_sub_f32 v32, v18, v26
    v_fmac_f32 v27, v32, v32
    v_sub_f32 v33, v19, v26
    v_fmac_f32 v28, v33, v33
    v_sub_f32 v30, v20, v26
    v_fmac_f32 v27, v30, v30
    v_sub_f32 v31, v21, v26
    v_fmac_f32 v28, v31, v31
    v_sub_f32 v32, v22, v26
    v_fmac_f32 v27, v32, v32
    v_sub_f32 v33, v23, v26
    v_fmac_f32 v28, v33, v33
    v_sub_f32 v30, v24, v26
    v_fmac_f32 v27, v30, v30
    v_sub_f32 v31, v25, v26
    v_fmac_f32 v28, v31, v31
    v_add_f32 v27, v27, v28
    s_nop 1
    v_add_f32 v27, v27, v27 quad_perm:[1,0,3,2] row_mask:0xf bank_mask:0xf
    s_nop 1
    v_add_f32 v27, v27, v27 quad_perm:[2,3,0,1] row_mask:0xf bank_mask:0xf
    s_nop 1
    v_add_f32 v27, v27, v27 row_half_mirror row_mask:0xf bank_mask:0xf
    s_nop 1
    v_add_f32 v27, v27, v27 row_mirror row_mask:0xf bank_mask:0xf
    v_mov_b32 v3, v27
    s_nop 1
    v_permlane16_swap_b32 v27, v3
    v_add_f32 v27, v27, v3
    v_mul_f32 v3, s54, v27
    v_fma_f32 v27, -v3, s55, v27
    v_fma_f32 v27, v27, s54, v3
    v_cvt_pk_bf16_f32 v26, v26, v27
    v_and_b32 v27, 0xffff0000, v26
    v_lshlrev_b32 v26, 16, v26
    v_add_f32 v27, 0x3727c5ac, v27
    v_cvt_pk_bf16_f32 v27, v27, v27
    v_lshlrev_b32 v27, 16, v27
    v_sqrt_f32 v28, v27
    v_rsq_f32 v29, v27
    v_fma_f32 v30, -v28, v28, v27
    v_mul_f32 v29, 0.5, v29
    v_fma_f32 v28, v30, v29, v28
    v_cvt_pk_bf16_f32 v28, v28, v28
    v_lshlrev_b32 v28, 16, v28
    v_rcp_f32 v29, v28
    v_sub_f32 v8, v8, v26
    v_sub_f32 v9, v9, v26
    v_sub_f32 v10, v10, v26
    v_sub_f32 v11, v11, v26
    v_sub_f32 v12, v12, v26
    v_sub_f32 v13, v13, v26
    v_sub_f32 v14, v14, v26
    v_sub_f32 v15, v15, v26
    v_sub_f32 v16, v16, v26
    v_sub_f32 v17, v17, v26
    v_sub_f32 v18, v18, v26
    v_sub_f32 v19, v19, v26
    v_sub_f32 v20, v20, v26
    v_sub_f32 v21, v21, v26
    v_sub_f32 v22, v22, v26
    v_sub_f32 v23, v23, v26
    v_sub_f32 v24, v24, v26
    v_sub_f32 v25, v25, v26
    v_cvt_pk_bf16_f32 v72, v8, v9
    v_cvt_pk_bf16_f32 v73, v10, v11
    v_cvt_pk_bf16_f32 v74, v12, v13
    v_cvt_pk_bf16_f32 v75, v14, v15
    v_cvt_pk_bf16_f32 v76, v16, v17
    v_cvt_pk_bf16_f32 v77, v18, v19
    v_cvt_pk_bf16_f32 v78, v20, v21
    v_cvt_pk_bf16_f32 v79, v22, v23
    v_cvt_pk_bf16_f32 v80, v24, v25
    v_lshlrev_b32 v8, 16, v72
    v_and_b32 v9, 0xffff0000, v72
    v_lshlrev_b32 v10, 16, v73
    v_and_b32 v11, 0xffff0000, v73
    v_lshlrev_b32 v12, 16, v74
    v_and_b32 v13, 0xffff0000, v74
    v_lshlrev_b32 v14, 16, v75
    v_and_b32 v15, 0xffff0000, v75
    v_lshlrev_b32 v16, 16, v76
    v_and_b32 v17, 0xffff0000, v76
    v_lshlrev_b32 v18, 16, v77
    v_and_b32 v19, 0xffff0000, v77
    v_lshlrev_b32 v20, 16, v78
    v_and_b32 v21, 0xffff0000, v78
    v_lshlrev_b32 v22, 16, v79
    v_and_b32 v23, 0xffff0000, v79
    v_lshlrev_b32 v24, 16, v80
    v_and_b32 v25, 0xffff0000, v80
    v_mul_f32 v30, v8, v29
    v_fma_f32 v8, -v30, v28, v8
    v_fma_f32 v8, v8, v29, v30
    v_mul_f32 v31, v9, v29
    v_fma_f32 v9, -v31, v28, v9
    v_fma_f32 v9, v9, v29, v31
    v_mul_f32 v32, v10, v29
    v_fma_f32 v10, -v32, v28, v10
    v_fma_f32 v10, v10, v29, v32
    v_mul_f32 v33, v11, v29
    v_fma_f32 v11, -v33, v28, v11
    v_fma_f32 v11, v11, v29, v33
    v_mul_f32 v30, v12, v29
    v_fma_f32 v12, -v30, v28, v12
    v_fma_f32 v12, v12, v29, v30
    v_mul_f32 v31, v13, v29
    v_fma_f32 v13, -v31, v28, v13
    v_fma_f32 v13, v13, v29, v31
    v_mul_f32 v32, v14, v29
    v_fma_f32 v14, -v32, v28, v14
    v_fma_f32 v14, v14, v29, v32
    v_mul_f32 v33, v15, v29
    v_fma_f32 v15, -v33, v28, v15
    v_fma_f32 v15, v15, v29, v33
    v_mul_f32 v30, v16, v29
    v_fma_f32 v16, -v30, v28, v16
    v_fma_f32 v16, v16, v29, v30
    v_mul_f32 v31, v17, v29
    v_fma_f32 v17, -v31, v28, v17
    v_fma_f32 v17, v17, v29, v31
    v_mul_f32 v32, v18, v29
    v_fma_f32 v18, -v32, v28, v18
    v_fma_f32 v18, v18, v29, v32
    v_mul_f32 v33, v19, v29
    v_fma_f32 v19, -v33, v28, v19
    v_fma_f32 v19, v19, v29, v33
    v_mul_f32 v30, v20, v29
    v_fma_f32 v20, -v30, v28, v20
    v_fma_f32 v20, v20, v29, v30
    v_mul_f32 v31, v21, v29
    v_fma_f32 v21, -v31, v28, v21
    v_fma_f32 v21, v21, v29, v31
    v_mul_f32 v32, v22, v29
    v_fma_f32 v22, -v32, v28, v22
    v_fma_f32 v22, v22, v29, v32
    v_mul_f32 v33, v23, v29
    v_fma_f32 v23, -v33, v28, v23
    v_fma_f32 v23, v23, v29, v33
    v_mul_f32 v30, v24, v29
    v_fma_f32 v24, -v30, v28, v24
    v_fma_f32 v24, v24, v29, v30
    v_mul_f32 v31, v25, v29
    v_fma_f32 v25, -v31, v28, v25
    v_fma_f32 v25, v25, v29, v31
    v_cvt_pk_bf16_f32 v72, v8, v9
    v_cvt_pk_bf16_f32 v73, v10, v11
    v_cvt_pk_bf16_f32 v74, v12, v13
    v_cvt_pk_bf16_f32 v75, v14, v15
    v_cvt_pk_bf16_f32 v76, v16, v17
    v_cvt_pk_bf16_f32 v77, v18, v19
    v_cvt_pk_bf16_f32 v78, v20, v21
    v_cvt_pk_bf16_f32 v79, v22, v23
    v_cvt_pk_bf16_f32 v80, v24, v25
    v_and_b32 v4, 0xe0, v0
    v_add_u32 v4, 110592, v4
    v_add_u32 v67, v67, v4
    v_add_u32 v68, v68, v4
    ds_write_b128 v67, v[72:75]
    ds_write_b128 v67, v[76:79] offset:512
    ds_write_b32 v68, v80 offset:1024
    s_mov_b64 exec, 1
    ds_add_u32 v64, v69 offset:20
    s_mov_b64 exec, -1
    v_lshrrev_b32 v4, 4, v1
    v_bfe_u32 v5, v0, 2, 2
    v_lshl_add_u32 v6, v4, 3, v5
    v_and_b32 v7, 2, v5
    v_and_b32 v26, 1, v4
    v_lshl_or_b32 v7, v26, 2, v7
    v_lshrrev_b32 v26, 5, v0
    v_and_b32 v26, 6, v26
    v_bfe_u32 v27, v0, 1, 1
    v_or_b32 v26, v26, v27
    v_xor_b32 v7, v7, v26
    v_lshlrev_b32 v7, 4, v7
    v_and_b32 v27, 1, v0
    v_lshl_add_u32 v7, v27, 3, v7
    v_lshl_add_u32 v70, v6, 7, v7
    v_add_u32 v82, 0x10000, v70
    v_and_b32 v5, 7, v0
    s_movk_i32 s3, 1184
    v_mul_u32_u24 v71, s3, v5
    v_lshl_add_u32 v71, v4, 4, v71
    v_add_u32 v71, 110592, v71
    s_movk_i32 s3, 608
    v_mul_u32_u24 v83, s3, v5
    v_lshl_add_u32 v83, v4, 4, v83
    v_add_u32 v83, 120064, v83
    v_lshlrev_b32 v84, 6, v5
    v_lshl_add_u32 v84, v4, 4, v84
    s_lshl_b32 s3, s28, 3
    v_add_u32 v84, s3, v84
    s_lshl_b32 s3, s44, 11
    v_add_u32 v85, s3, v84
    s_cmp_lg_u32 s41, 0
    s_cbranch_scc1 L_P_notq
    s_lshr_b32 s3, s44, 2
    s_lshl_b32 s3, s3, 13
    s_and_b32 s44, s44, 3
    s_lshl_b32 s44, s44, 8
    s_add_u32 s3, s3, s44
    s_add_u32 s3, s3, s28
    v_lshlrev_b32 v85, 10, v5
    v_lshl_add_u32 v85, v4, 4, v85
    v_add_u32 v85, s3, v85
L_P_notq:
    s_mov_b32 s62, 0x400000
L_spin_46:
    ds_read_b32 v3, v64 offset:20
    s_sub_u32 s62, s62, 1
    s_cbranch_scc1 L_spun_47
    s_waitcnt lgkmcnt(0)
    v_readfirstlane_b32 s3, v3
    s_nop 0
    s_cmp_lt_u32 s3, 4
    s_cbranch_scc1 L_spin_46
L_spun_47:
    s_waitcnt lgkmcnt(0)
    ds_read_b128 v[140:143], v71 offset:0
    ds_read_b128 v[144:147], v71 offset:64
    ds_read_b128 v[148:151], v71 offset:128
    ds_read_b128 v[152:155], v71 offset:192
    ds_read_b128 v[156:159], v71 offset:256
    ds_read_b128 v[160:163], v71 offset:320
    ds_read_b128 v[164:167], v71 offset:384
    ds_read_b128 v[168:171], v71 offset:448
    ds_read_b128 v[172:175], v71 offset:512
    ds_read_b128 v[176:179], v71 offset:576
    ds_read_b128 v[180:183], v71 offset:640
    ds_read_b128 v[184:187], v71 offset:704
    s_waitcnt lgkmcnt(0)
    ds_read_b128 v[188:191], v71 offset:768
    ds_read_b128 v[192:195], v71 offset:832
    ds_read_b128 v[196:199], v71 offset:896
    ds_read_b128 v[200:203], v71 offset:960
    ds_read_b128 v[204:207], v71 offset:1024
    ds_read_b128 v[208:211], v71 offset:1088
    s_waitcnt vmcnt(0) lgkmcnt(0)
    v_cmp_ne_u32 vcc, s57, v81
    s_nop 0
    s_or_b32 s59, vcc_lo, vcc_hi
    s_mov_b64 exec, 1
    ds_add_u32 v64, v69 offset:0
    s_mov_b64 exec, -1
    s_mov_b32 s62, 0x400000
L_spin_48:
    ds_read_b32 v3, v64 offset:0
    s_sub_u32 s62, s62, 1
    s_cbranch_scc1 L_spun_49
    s_waitcnt lgkmcnt(0)
    v_readfirstlane_b32 s3, v3
    s_nop 0
    s_cmp_lt_u32 s3, 4
    s_cbranch_scc1 L_spin_48
L_spun_49:
    s_waitcnt lgkmcnt(0)
    ds_read_b64_tr_b16 v[8:9], v70 offset:0
    ds_read_b64_tr_b16 v[10:11], v70 offset:512
    ds_read_b64_tr_b16 v[12:13], v70 offset:4096
    ds_read_b64_tr_b16 v[14:15], v70 offset:4608
    ds_read_b64_tr_b16 v[16:17], v70 offset:8192
    ds_read_b64_tr_b16 v[18:19], v70 offset:8704
    ds_read_b64_tr_b16 v[20:21], v70 offset:12288
    ds_read_b64_tr_b16 v[22:23], v70 offset:12800
    ds_read_b64_tr_b16 v[24:25], v70 offset:16384
    ds_read_b64_tr_b16 v[26:27], v70 offset:16896
    ds_read_b64_tr_b16 v[28:29], v70 offset:20480
    ds_read_b64_tr_b16 v[30:31], v70 offset:20992
    ds_read_b64_tr_b16 v[32:33], v70 offset:24576
    ds_read_b64_tr_b16 v[34:35], v70 offset:25088
    s_waitcnt lgkmcnt(12)
    v_mfma_f32_16x16x32_bf16 v[4:7], v[8:11], v[140:143], 0
    ds_read_b64_tr_b16 v[36:37], v70 offset:28672
    ds_read_b64_tr_b16 v[38:39], v70 offset:29184
    s_waitcnt lgkmcnt(12)
    v_mfma_f32_16x16x32_bf16 v[4:7], v[12:15], v[144:147], v[4:7]
    ds_read_b64_tr_b16 v[8:9], v70 offset:32768
    ds_read_b64_tr_b16 v[10:11], v70 offset:33280
    s_waitcnt lgkmcnt(12)
    v_mfma_f32_16x16x32_bf16 v[4:7], v[16:19], v[148:151], v[4:7]
    ds_read_b64_tr_b16 v[12:13], v70 offset:36864
    ds_read_b64_tr_b16 v[14:15], v70 offset:37376
    s_waitcnt lgkmcnt(12)
    v_mfma_f32_16x16x32_bf16 v[4:7], v[20:23], v[152:155], v[4:7]
    ds_read_b64_tr_b16 v[16:17], v70 offset:40960
    ds_read_b64_tr_b16 v[18:19], v70 offset:41472
    s_waitcnt lgkmcnt(12)
    v_mfma_f32_16x16x32_bf16 v[4:7], v[24:27], v[156:159], v[4:7]
    ds_read_b64_tr_b16 v[20:21], v70 offset:45056
    ds_read_b64_tr_b16 v[22:23], v70 offset:45568
    s_waitcnt lgkmcnt(12)
    v_mfma_f32_16x16x32_bf16 v[4:7], v[28:31], v[160:163], v[4:7]
    ds_read_b64_tr_b16 v[24:25], v70 offset:49152
    ds_read_b64_tr_b16 v[26:27], v70 offset:49664
    s_waitcnt lgkmcnt(12)
    v_mfma_f32_16x16x32_bf16 v[4:7], v[32:35], v[164:167], v[4:7]
    ds_read_b64_tr_b16 v[28:29], v70 offset:53248
    ds_read_b64_tr_b16 v[30:31], v70 offset:53760
    s_waitcnt lgkmcnt(12)
    v_mfma_f32_16x16x32_bf16 v[4:7], v[36:39], v[168:171], v[4:7]
    ds_read_b64_tr_b16 v[32:33], v70 offset:57344
    ds_read_b64_tr_b16 v[34:35], v70 offset:57856
    s_waitcnt lgkmcnt(12)
    v_mfma_f32_16x16x32_bf16 v[4:7], v[8:11], v[172:175], v[4:7]
    ds_read_b64_tr_b16 v[36:37], v70 offset:61440
    ds_read_b64_tr_b16 v[38:39], v70 offset:61952
    s_waitcnt lgkmcnt(12)
    v_mfma_f32_16x16x32_bf16 v[4:7], v[12:15], v[176:179], v[4:7]
    ds_read_b64_tr_b16 v[8:9], v82 offset:0
    ds_read_b64_tr_b16 v[10:11], v82 offset:512
    s_waitcnt lgkmcnt(12)
    v_mfma_f32_16x16x32_bf16 v[4:7], v[16:19], v[180:183], v[4:7]
    ds_read_b64_tr_b16 v[12:13], v82 offset:4096
    ds_read_b64_tr_b16 v[14:15], v82 offset:4608
    s_waitcnt lgkmcnt(12)
    v_mfma_f32_16x16x32_bf16 v[4:7], v[20:23], v[184:187], v[4:7]
    s_waitcnt lgkmcnt(10)
    v_mfma_f32_16x16x32_bf16 v[4:7], v[24:27], v[188:191], v[4:7]
    s_waitcnt lgkmcnt(8)
    v_mfma_f32_16x16x32_bf16 v[4:7], v[28:31], v[192:195], v[4:7]
    s_waitcnt lgkmcnt(6)
    v_mfma_f32_16x16x32_bf16 v[4:7], v[32:35], v[196:199], v[4:7]
    s_waitcnt lgkmcnt(4)
    v_mfma_f32_16x16x32_bf16 v[4:7], v[36:39], v[200:203], v[4:7]
    s_waitcnt lgkmcnt(2)
    v_mfma_f32_16x16x32_bf16 v[4:7], v[8:11], v[204:207], v[4:7]
    s_waitcnt lgkmcnt(0)
    v_mfma_f32_16x16x32_bf16 v[4:7], v[12:15], v[208:211], v[4:7]
    s_nop 7
    v_cvt_pk_bf16_f32 v92, v4, v5
    v_cvt_pk_bf16_f32 v94, v6, v7
    s_cmp_lg_u32 s41, 2
    s_cbranch_scc1 L_P_nomul
    s_cmp_lg_u32 s28, 0
    s_cbranch_scc1 L_noqU
    s_bfe_u32 s31, s2, 0x30004
    s_bfe_u32 s3, s2, 0x10003
    s_lshl1_add_u32 s58, s29, s3
    s_lshl3_add_u32 s3, s58, s31
    s_lshl_b32 s3, s3, 10
    v_lshl_add_u32 v5, v1, 4, s3
    v_lshlrev_b32 v4, 3, v1
    v_add_u32 v4, 124928, v4
    s_mov_b32 s62, 0x400000
L_spin_50:
    ds_read_b32 v3, v64 offset:32
    s_sub_u32 s62, s62, 1
    s_cbranch_scc1 L_spun_51
    s_waitcnt lgkmcnt(0)
    v_readfirstlane_b32 s3, v3
    s_nop 0
    s_cmp_lt_u32 s3, 1
    s_cbranch_scc1 L_spin_50
L_spun_51:
    s_waitcnt lgkmcnt(0)
    s_mov_b32 s62, 0x20000
L_poll_52:
    global_load_dwordx4 v[8:11], v5, s[26:27] sc1
    s_sub_u32 s62, s62, 1
    s_cbranch_scc1 L_polled_53
    s_waitcnt vmcnt(0)
    v_xor_b32 v3, s63, v9
    v_xor_b32 v2, s63, v11
    v_or_b32 v3, v3, v2
    v_cmp_ne_u32 vcc, 0, v3
    s_cbranch_vccnz L_poll_52
L_polled_53:
    s_waitcnt vmcnt(0)
    ds_write2_b32 v4, v8, v10 offset1:1
    s_mov_b64 exec, 1
    ds_add_u32 v64, v69 offset:36
    s_mov_b64 exec, -1
L_noqU:
    s_mov_b32 s62, 0x400000
L_spin_54:
    ds_read_b32 v3, v64 offset:32
    s_sub_u32 s62, s62, 1
    s_cbranch_scc1 L_spun_55
    s_waitcnt lgkmcnt(0)
    v_readfirstlane_b32 s3, v3
    s_nop 0
    s_cmp_lt_u32 s3, 1
    s_cbranch_scc1 L_spin_54
L_spun_55:
    s_waitcnt lgkmcnt(0)
    v_subrev_u32 v4, 147456, v85
    s_mov_b32 s62, 0x20000
L_poll_56:
    global_load_dwordx4 v[8:11], v4, s[26:27] sc1
    s_sub_u32 s62, s62, 1
    s_cbranch_scc1 L_polled_57
    s_waitcnt vmcnt(0)
    v_xor_b32 v3, s63, v9
    v_xor_b32 v2, s63, v11
    v_or_b32 v3, v3, v2
    v_cmp_ne_u32 vcc, 0, v3
    s_cbranch_vccnz L_poll_56
L_polled_57:
    s_waitcnt vmcnt(0)
    v_lshlrev_b32 v40, 16, v92
    v_and_b32 v41, 0xffff0000, v92
    v_lshlrev_b32 v42, 16, v8
    v_and_b32 v43, 0xffff0000, v8
    v_pk_mul_f32 v[40:41], v[40:41], v[42:43]
    v_cvt_pk_bf16_f32 v92, v40, v41
    v_lshlrev_b32 v40, 16, v94
    v_and_b32 v41, 0xffff0000, v94
    v_lshlrev_b32 v42, 16, v10
    v_and_b32 v43, 0xffff0000, v10
    v_pk_mul_f32 v[40:41], v[40:41], v[42:43]
    v_cvt_pk_bf16_f32 v94, v40, v41
L_P_nomul:
    s_mov_b64 exec, s[60:61]
    s_cmp_eq_u32 s59, 0
    s_cbranch_scc0 L_far_58
    global_store_dwordx4 v85, v[92:95], s[26:27]
    s_branch L_st_59
L_far_58:
    global_store_dwordx4 v85, v[92:95], s[26:27] sc1
L_st_59:
    s_mov_b64 exec, -1
    s_cmp_eq_u32 s41, 2
    s_cbranch_scc1 L_noqP
    s_cmp_lg_u32 s28, 0
    s_cbranch_scc1 L_noqP
    s_bfe_u32 s31, s2, 0x30004
    s_bfe_u32 s3, s2, 0x10003
    s_lshl1_add_u32 s58, s29, s3
    s_lshl3_add_u32 s3, s58, s31
    s_lshl_b32 s3, s3, 10
    v_lshl_add_u32 v5, v1, 4, s3
    v_lshlrev_b32 v4, 3, v1
    v_add_u32 v4, 124928, v4
    s_mov_b32 s62, 0x400000
L_spin_60:
    ds_read_b32 v3, v64 offset:32
    s_sub_u32 s62, s62, 1
    s_cbranch_scc1 L_spun_61
    s_waitcnt lgkmcnt(0)
    v_readfirstlane_b32 s3, v3
    s_nop 0
    s_cmp_lt_u32 s3, 1
    s_cbranch_scc1 L_spin_60
L_spun_61:
    s_waitcnt lgkmcnt(0)
    s_mov_b32 s62, 0x20000
L_poll_62:
    global_load_dwordx4 v[8:11], v5, s[26:27] sc1
    s_sub_u32 s62, s62, 1
    s_cbranch_scc1 L_polled_63
    s_waitcnt vmcnt(0)
    v_xor_b32 v3, s63, v9
    v_xor_b32 v2, s63, v11
    v_or_b32 v3, v3, v2
    v_cmp_ne_u32 vcc, 0, v3
    s_cbranch_vccnz L_poll_62
L_polled_63:
    s_waitcnt vmcnt(0)
    ds_write2_b32 v4, v8, v10 offset1:1
    s_mov_b64 exec, 1
    ds_add_u32 v64, v69 offset:36
    s_mov_b64 exec, -1
L_noqP:
    v_mov_b32 v120, s63
    v_lshrrev_b32 v121, 8, v120
    v_lshrrev_b32 v122, 16, v120
    v_lshrrev_b32 v123, 24, v120
    s_cmpk_ge_u32 s2, 144
    s_cbranch_scc1 L_N
    s_cmp_ge_u32 s30, 9
    s_cselect_b32 s47, 1, 0
    s_cselect_b32 s3, 9, 0
    s_sub_u32 s48, s30, s3
    s_lshl1_add_u32 s47, s29, s47
    s_mul_i32 s50, s47, 331776
    s_lshl_b32 s3, s48, 7
    s_sub_u32 s34, 331776, s3
    s_add_u32 s50, s50, s3
    s_add_u32 s32, s20, s50
    s_addc_u32 s33, s21, 0
    s_lshl_b32 s53, s48, 16
    s_add_u32 s53, s53, 851968
    s_lshl_b32 s3, s47, 11
    s_add_u32 s3, s3, s53
    s_add_u32 s3, s3, 32768
    v_add_u32 v84, s3, v84
    s_lshr_b32 s54, s28, 6
    s_lshl2_add_u32 s54, s48, s54
    s_cmp_ge_u32 s54, 18
    s_cselect_b32 s55, 18, 0
    s_sub_u32 s3, s54, s55
    s_cmp_ge_u32 s54, 18
    s_cselect_b32 s55, 8192, 0
    s_lshl_b32 s3, s3, 15
    s_add_u32 s3, s3, s55
    s_add_u32 s3, s3, 851968
    s_lshl_b32 s54, s47, 9
    s_add_u32 s3, s3, s54
    s_add_u32 s3, s3, 16384
    v_and_b32 v84, 0x1ff, v84
    v_add_u32 v84, s3, v84
    v_add_u32 v70, 73728, v70
    s_cmp_eq_u32 s28, 0
    s_cbranch_scc1 L_P_noh
    s_mul_i32 s3, s47, 9216
    s_mul_i32 s54, s28, 48
    s_add_u32 s3, s3, s54
    s_add_u32 s3, s3, 275456
    v_lshl_add_u32 v4, v1, 4, s3
    s_mov_b32 s62, 0x400000
L_spin_64:
    ds_read_b32 v3, v64 offset:4
    s_sub_u32 s62, s62, 1
    s_cbranch_scc1 L_spun_65
    s_waitcnt lgkmcnt(0)
    v_readfirstlane_b32 s3, v3
    s_nop 0
    s_cmp_lt_u32 s3, 1
    s_cbranch_scc1 L_spin_64
L_spun_65:
    s_waitcnt lgkmcnt(0)
    s_mov_b32 s62, 0x20000
L_poll_66:
    global_load_dwordx4 v[8:11], v4, s[26:27] offset:0 sc1
    global_load_dwordx4 v[12:15], v4, s[26:27] offset:1024 sc1
    global_load_dwordx4 v[16:19], v4, s[26:27] offset:2048 sc1
    s_sub_u32 s62, s62, 1
    s_cbranch_scc1 L_polled_67
    s_waitcnt vmcnt(0)
    v_xor_b32 v3, s63, v9
    v_xor_b32 v2, s63, v11
    v_bitop3_b32 v3, v13, s63, v3 bitop3:0xbe
    v_bitop3_b32 v2, v15, s63, v2 bitop3:0xbe
    v_bitop3_b32 v3, v17, s63, v3 bitop3:0xbe
    v_bitop3_b32 v2, v19, s63, v2 bitop3:0xbe
    v_or_b32 v3, v3, v2
    v_cmp_ne_u32 vcc, 0, v3
    s_cbranch_vccnz L_poll_66
L_polled_67:
    s_waitcnt vmcnt(0)
    v_bfe_u32 v4, v0, 2, 3
    s_movk_i32 s3, 608
    v_mul_u32_u24 v4, s3, v4
    v_and_b32 v5, 32, v0
    v_add_u32 v4, v5, v4
    v_and_b32 v5, 3, v0
    v_lshl_add_u32 v4, v5, 3, v4
    s_mul_i32 s3, s28, 3
    s_add_u32 s3, s3, 119872
    v_add_u32 v4, s3, v4
    ds_write2_b32 v4, v8, v10 offset1:1
    ds_write2_b32 v4, v12, v14 offset0:16 offset1:17
    ds_write2_b32 v4, v16, v18 offset0:32 offset1:33
    s_mov_b64 exec, 1
    ds_add_u32 v64, v69 offset:24
    s_mov_b64 exec, -1
L_P_noh:
    s_mov_b32 s62, 0x400000
L_spin_68:
    ds_read_b32 v3, v64 offset:24
    s_sub_u32 s62, s62, 1
    s_cbranch_scc1 L_spun_69
    s_waitcnt lgkmcnt(0)
    v_readfirstlane_b32 s3, v3
    s_nop 0
    s_cmp_lt_u32 s3, 3
    s_cbranch_scc1 L_spin_68
L_spun_69:
    s_waitcnt lgkmcnt(0)
    ds_read_b128 v[140:143], v83 offset:0
    ds_read_b128 v[144:147], v83 offset:64
    ds_read_b128 v[148:151], v83 offset:128
    ds_read_b128 v[152:155], v83 offset:192
    ds_read_b128 v[156:159], v83 offset:256
    ds_read_b128 v[160:163], v83 offset:320
    ds_read_b128 v[164:167], v83 offset:384
    ds_read_b128 v[168:171], v83 offset:448
    ds_read_b128 v[172:175], v83 offset:512
    s_mov_b32 s62, 0x400000
L_spin_70:
    ds_read_b32 v3, v64 offset:8
    s_sub_u32 s62, s62, 1
    s_cbranch_scc1 L_spun_71
    s_waitcnt lgkmcnt(0)
    v_readfirstlane_b32 s3, v3
    s_nop 0
    s_cmp_lt_u32 s3, 4
    s_cbranch_scc1 L_spin_70
L_spun_71:
    s_waitcnt lgkmcnt(0)
    s_mov_b32 s54, 0
    s_lshl_b32 s55, s28, 4
    s_add_u32 s55, s55, 73728
    s_add_u32 s56, s55, 24576
L_dma_72:
    s_mov_b32 m0, s55
    s_add_u32 s55, s55, 4096
    buffer_load_dwordx4 v66, s[32:35], s54 offen nt lds
    s_add_u32 s54, s54, 36864
L_dmd_73:
    s_cmp_lt_u32 s55, s56
    s_cbranch_scc1 L_dma_72
    s_mov_b32 s62, 0x400000
L_spin_74:
    ds_read_b32 v3, v64 offset:40
    s_sub_u32 s62, s62, 1
    s_cbranch_scc1 L_spun_75
    s_waitcnt lgkmcnt(0)
    v_readfirstlane_b32 s3, v3
    s_nop 0
    s_cmp_lt_u32 s3, 1
    s_cbranch_scc1 L_spin_74
L_spun_75:
    s_waitcnt lgkmcnt(0)
    s_add_u32 s56, s55, 12288
L_dma_76:
    s_mov_b32 m0, s55
    s_add_u32 s55, s55, 4096
    buffer_load_dwordx4 v66, s[32:35], s54 offen nt lds
    s_add_u32 s54, s54, 36864
L_dmd_77:
    s_cmp_lt_u32 s55, s56
    s_cbranch_scc1 L_dma_76
    s_movk_i32 s56, 0xff
    s_waitcnt vmcnt(3)
    s_barrier
    ds_read_b64_tr_b16 v[8:9], v70 offset:0
    ds_read_b64_tr_b16 v[10:11], v70 offset:512
    ds_read_b64_tr_b16 v[12:13], v70 offset:4096
    ds_read_b64_tr_b16 v[14:15], v70 offset:4608
    ds_read_b64_tr_b16 v[16:17], v70 offset:8192
    ds_read_b64_tr_b16 v[18:19], v70 offset:8704
    ds_read_b64_tr_b16 v[20:21], v70 offset:12288
    ds_read_b64_tr_b16 v[22:23], v70 offset:12800
    ds_read_b64_tr_b16 v[24:25], v70 offset:16384
    ds_read_b64_tr_b16 v[26:27], v70 offset:16896
    ds_read_b64_tr_b16 v[28:29], v70 offset:20480
    ds_read_b64_tr_b16 v[30:31], v70 offset:20992
    s_waitcnt lgkmcnt(10)
    v_mfma_f32_16x16x32_bf16 v[4:7], v[8:11], v[140:143], 0
    s_waitcnt lgkmcnt(8)
    v_mfma_f32_16x16x32_bf16 v[4:7], v[12:15], v[144:147], v[4:7]
    s_waitcnt lgkmcnt(6)
    v_mfma_f32_16x16x32_bf16 v[4:7], v[16:19], v[148:151], v[4:7]
    s_waitcnt lgkmcnt(4)
    v_mfma_f32_16x16x32_bf16 v[4:7], v[20:23], v[152:155], v[4:7]
    s_waitcnt lgkmcnt(2)
    v_mfma_f32_16x16x32_bf16 v[4:7], v[24:27], v[156:159], v[4:7]
    s_waitcnt lgkmcnt(0)
    v_mfma_f32_16x16x32_bf16 v[4:7], v[28:31], v[160:163], v[4:7]
    s_waitcnt vmcnt(0)
    s_barrier
    ds_read_b64_tr_b16 v[32:33], v70 offset:24576
    ds_read_b64_tr_b16 v[34:35], v70 offset:25088
    ds_read_b64_tr_b16 v[36:37], v70 offset:28672
    ds_read_b64_tr_b16 v[38:39], v70 offset:29184
    ds_read_b64_tr_b16 v[8:9], v70 offset:32768
    ds_read_b64_tr_b16 v[10:11], v70 offset:33280
    s_waitcnt lgkmcnt(4)
    v_mfma_f32_16x16x32_bf16 v[4:7], v[32:35], v[164:167], v[4:7]
    s_waitcnt lgkmcnt(2)
    v_mfma_f32_16x16x32_bf16 v[4:7], v[36:39], v[168:171], v[4:7]
    s_waitcnt lgkmcnt(0)
    v_mfma_f32_16x16x32_bf16 v[4:7], v[8:11], v[172:175], v[4:7]
    s_nop 7
    v_add_u32 v4, 0x80, v4
    v_add_u32 v5, 0x80, v5
    v_add_u32 v6, 0x80, v6
    v_add_u32 v7, 0x80, v7
    v_bfi_b32 v4, s56, v120, v4
    v_bfi_b32 v5, s56, v121, v5
    v_bfi_b32 v6, s56, v122, v6
    v_bfi_b32 v7, s56, v123, v7
    s_mov_b64 exec, s[60:61]
    global_store_dwordx4 v84, v[4:7], s[26:27] sc1
    s_mov_b64 exec, -1
    s_branch L_W_done
L_N:
    s_lshr_b32 s3, s28, 3
    s_add_u32 s49, s30, s3
    s_sub_u32 s49, s49, 18
    s_add_u32 s3, s2, s28
    s_cmpk_lg_u32 s3, 353
    s_cbranch_scc1 L_N_norace
    v_and_b32 v4, 1, v0
    v_lshlrev_b32 v4, 13, v4
    v_lshrrev_b32 v5, 1, v1
    v_lshl_add_u32 v4, v5, 8, v4
    v_add_u32 v4, 835584, v4
    s_mov_b64 exec, 1023
    global_store_dword v4, v93, s[26:27] sc1
    s_mov_b64 exec, -1
    s_mov_b32 s54, 0
    s_not_b32 s55, s63
    s_waitcnt vmcnt(0)
    s_mov_b32 s92, s55
    s_mov_b32 s93, s55
    s_load_dword s92, s[26:27], 835584
    s_load_dword s93, s[26:27], 843776
    s_waitcnt lgkmcnt(1)
    s_cmp_eq_u32 s93, s63
    s_addc_u32 s54, s54, 0
    s_cmp_eq_u32 s92, s63
    s_subb_u32 s54, s54, 0
    s_waitcnt lgkmcnt(0)
    s_mov_b32 s92, s55
    s_mov_b32 s93, s55
    s_load_dword s93, s[26:27], 844032
    s_load_dword s92, s[26:27], 835840
    s_waitcnt lgkmcnt(1)
    s_cmp_eq_u32 s93, s63
    s_addc_u32 s54, s54, 0
    s_cmp_eq_u32 s92, s63
    s_subb_u32 s54, s54, 0
    s_waitcnt lgkmcnt(0)
    s_mov_b32 s92, s55
    s_mov_b32 s93, s55
    s_load_dword s92, s[26:27], 836096
    s_load_dword s93, s[26:27], 844288
    s_waitcnt lgkmcnt(1)
    s_cmp_eq_u32 s93, s63
    s_addc_u32 s54, s54, 0
    s_cmp_eq_u32 s92, s63
    s_subb_u32 s54, s54, 0
    s_waitcnt lgkmcnt(0)
    s_mov_b32 s92, s55
    s_mov_b32 s93, s55
    s_load_dword s93, s[26:27], 844544
    s_load_dword s92, s[26:27], 836352
    s_waitcnt lgkmcnt(1)
    s_cmp_eq_u32 s93, s63
    s_addc_u32 s54, s54, 0
    s_cmp_eq_u32 s92, s63
    s_subb_u32 s54, s54, 0
    s_waitcnt lgkmcnt(0)
    s_mov_b32 s92, s55
    s_mov_b32 s93, s55
    s_load_dword s92, s[26:27], 836608
    s_load_dword s93, s[26:27], 844800
    s_waitcnt lgkmcnt(1)
    s_cmp_eq_u32 s93, s63
    s_addc_u32 s54, s54, 0
    s_cmp_eq_u32 s92, s63
    s_subb_u32 s54, s54, 0
    s_waitcnt lgkmcnt(0)
    s_cmp_gt_i32 s54, 0
    s_addc_u32 s3, s63, 0
    v_mov_b32 v4, 831488
    v_mov_b32 v5, s3
    s_mov_b64 exec, 1
    global_store_dword v4, v5, s[26:27] sc1
    s_mov_b64 exec, -1
L_N_norace:
    s_cmp_ge_u32 s49, 18
    s_cbranch_scc1 L_W_done
    s_and_b32 s3, s2, 7
    s_mul_i32 s3, s3, 18
    s_add_u32 s49, s49, s3
    s_mov_b32 s62, 0x400000
L_spin_78:
    ds_read_b32 v3, v64 offset:4
    s_sub_u32 s62, s62, 1
    s_cbranch_scc1 L_spun_79
    s_waitcnt lgkmcnt(0)
    v_readfirstlane_b32 s3, v3
    s_nop 0
    s_cmp_lt_u32 s3, 1
    s_cbranch_scc1 L_spin_78
L_spun_79:
    s_waitcnt lgkmcnt(0)
    v_mov_b32 v4, 831488
    s_mov_b32 s62, 0x20000
L_N_dec:
    global_load_dword v5, v4, s[26:27] sc1
    s_sub_u32 s62, s62, 1
    s_cbranch_scc1 L_N_got
    s_waitcnt vmcnt(0)
    v_readfirstlane_b32 s3, v5
    s_nop 0
    s_sub_u32 s3, s3, s63
    s_cmp_gt_u32 s3, 1
    s_cbranch_scc1 L_N_dec
L_N_got:
    s_waitcnt vmcnt(0)
    s_and_b32 s3, s3, 1
    s_mul_i32 s3, s3, 72
    s_add_u32 s49, s49, s3
    s_cmpk_ge_u32 s49, 144
    s_cselect_b32 s54, 144, 0
    s_sub_u32 s49, s49, s54
    s_and_b32 s50, s49, 15
    s_lshr_b32 s49, s49, 4
    v_lshrrev_b32 v4, 4, v1
    v_bfe_u32 v5, v0, 2, 1
    v_and_b32 v6, 3, v0
    v_lshl_add_u32 v4, v6, 2, v4
    s_movk_i32 s3, 576
    v_mad_u32_u24 v4, v5, s3, v4
    s_and_b32 s54, s50, 3
    s_lshr_b32 s55, s50, 2
    s_mul_i32 s3, s54, 1152
    s_lshl4_add_u32 s3, s55, s3
    s_lshl_b32 s56, s49, 6
    s_add_u32 s3, s3, s56
    v_add_lshl_u32 v124, v4, s3, 1
    global_load_ushort v125, v124, s[4:5]
    s_lshl_b32 s55, s55, 9
    s_lshl_b32 s54, s54, 7
    s_lshl_b32 s3, s49, 16
    s_add_u32 s3, s3, 851968
    s_add_u32 s3, s3, s55
    s_add_u32 s3, s3, s54
    s_add_u32 s36, s26, s3
    s_addc_u32 s37, s27, 0
    v_lshrrev_b32 v4, 3, v1
    v_and_b32 v5, 7, v0
    v_lshlrev_b32 v5, 4, v5
    v_lshl_add_u32 v130, v4, 11, v5
    v_add_u32 v131, 16384, v130
    v_add_u32 v132, 32768, v130
    v_add_u32 v133, 49152, v130
    s_lshr_b32 s55, s50, 2
    s_lshl2_add_u32 s55, s49, s55
    s_cmp_ge_u32 s55, 18
    s_cselect_b32 s56, 18, 0
    s_sub_u32 s3, s55, s56
    s_cmp_ge_u32 s55, 18
    s_cselect_b32 s56, 8192, 0
    s_lshl_b32 s3, s3, 15
    s_add_u32 s3, s3, s56
    s_add_u32 s3, s3, 851968
    s_add_u32 s3, s3, s54
    s_add_u32 s36, s26, s3
    s_addc_u32 s37, s27, 0
    v_lshl_add_u32 v130, v4, 9, v5
    v_add_u32 v131, 4096, v130
    v_add_u32 v132, 16384, v130
    v_add_u32 v133, 20480, v130
    s_barrier
    s_mov_b32 s54, 0x0c0c0400
    s_mov_b32 s55, 0x05040100
    s_mov_b32 s56, 0xffffff00
    s_mov_b32 s62, 0x20000
    s_waitcnt vmcnt(0)
    v_lshlrev_b32 v125, 16, v125
L_H0:
    global_load_dwordx4 v[16:19], v132, s[36:37] sc1
    global_load_dwordx4 v[20:23], v133, s[36:37] sc1
    global_load_dwordx4 v[8:11], v130, s[36:37] sc1
    global_load_dwordx4 v[12:15], v131, s[36:37] sc1
    s_sub_u32 s62, s62, 1
    s_cbranch_scc1 L_H1
    s_waitcnt vmcnt(0)
    v_perm_b32 v24, v17, v16, s54
    v_perm_b32 v25, v19, v18, s54
    v_perm_b32 v26, v21, v20, s54
    v_perm_b32 v27, v23, v22, s54
    v_perm_b32 v24, v25, v24, s55
    v_perm_b32 v26, v27, v26, s55
    v_cmp_ne_u32 vcc, s63, v24
    v_cmp_ne_u32 s[42:43], s63, v26
    s_nop 0
    s_or_b64 vcc, vcc, s[42:43]
    s_cbranch_scc1 L_H0
L_H1:
    s_waitcnt vmcnt(0)
    s_mov_b32 s62, 0x20000
    v_perm_b32 v24, v9, v8, s54
    v_perm_b32 v25, v11, v10, s54
    v_perm_b32 v26, v13, v12, s54
    v_perm_b32 v27, v15, v14, s54
    v_perm_b32 v24, v25, v24, s55
    v_perm_b32 v26, v27, v26, s55
    v_cmp_ne_u32 vcc, s63, v24
    v_cmp_ne_u32 s[42:43], s63, v26
    s_nop 0
    s_or_b64 vcc, vcc, s[42:43]
    s_cbranch_scc1 L_H2
    v_and_b32 v16, s56, v16
    v_and_b32 v17, s56, v17
    v_and_b32 v18, s56, v18
    v_and_b32 v19, s56, v19
    v_and_b32 v20, s56, v20
    v_and_b32 v21, s56, v21
    v_and_b32 v22, s56, v22
    v_and_b32 v23, s56, v23
    v_pk_add_f32 v[16:17], v[16:17], v[20:21]
    v_pk_add_f32 v[18:19], v[18:19], v[22:23]
    s_nop 1
    v_permlane32_swap_b32 v16, v18
    v_permlane32_swap_b32 v17, v19
    v_pk_add_f32 v[16:17], v[16:17], v[18:19]
    s_nop 1
    v_permlane16_swap_b32 v16, v17
    v_add_f32 v16, v16, v17
    s_nop 1
    v_add_f32 v16, v16, v16 row_ror:8 row_mask:0xf bank_mask:0xf
    v_cvt_pk_bf16_f32 v16, v16, v16
    v_lshlrev_b32 v16, 16, v16
    v_mul_f32 v29, 0xbfb8aa3b, v16
    v_exp_f32 v29, v29
    s_nop 0
    v_add_f32 v29, 1.0, v29
    v_rcp_f32 v30, v29
    s_nop 0
    v_mul_f32 v31, v16, v30
    v_fma_f32 v32, -v31, v29, v16
    v_fma_f32 v32, v32, v30, v31
    v_cmp_class_f32 vcc, v32, 3
    s_nop 1
    v_cndmask_b32 v31, v32, v31, vcc
    v_cvt_pk_bf16_f32 v31, v31, v31
    v_lshlrev_b32 v31, 16, v31
    s_branch L_H4
L_H2:
    global_load_dwordx4 v[8:11], v130, s[36:37] sc1
    global_load_dwordx4 v[12:15], v131, s[36:37] sc1
    v_and_b32 v16, s56, v16
    v_and_b32 v17, s56, v17
    v_and_b32 v18, s56, v18
    v_and_b32 v19, s56, v19
    v_and_b32 v20, s56, v20
    v_and_b32 v21, s56, v21
    v_and_b32 v22, s56, v22
    v_and_b32 v23, s56, v23
    v_pk_add_f32 v[16:17], v[16:17], v[20:21]
    v_pk_add_f32 v[18:19], v[18:19], v[22:23]
    s_nop 1
    v_permlane32_swap_b32 v16, v18
    v_permlane32_swap_b32 v17, v19
    v_pk_add_f32 v[16:17], v[16:17], v[18:19]
    s_nop 1
    v_permlane16_swap_b32 v16, v17
    v_add_f32 v16, v16, v17
    s_nop 1
    v_add_f32 v16, v16, v16 row_ror:8 row_mask:0xf bank_mask:0xf
    v_cvt_pk_bf16_f32 v16, v16, v16
    v_lshlrev_b32 v16, 16, v16
    v_mul_f32 v29, 0xbfb8aa3b, v16
    v_exp_f32 v29, v29
    s_nop 0
    v_add_f32 v29, 1.0, v29
    v_rcp_f32 v30, v29
    s_nop 0
    v_mul_f32 v31, v16, v30
    v_fma_f32 v32, -v31, v29, v16
    v_fma_f32 v32, v32, v30, v31
    v_cmp_class_f32 vcc, v32, 3
    s_nop 1
    v_cndmask_b32 v31, v32, v31, vcc
    v_cvt_pk_bf16_f32 v31, v31, v31
    v_lshlrev_b32 v31, 16, v31
L_H3:
    s_waitcnt vmcnt(0)
    v_perm_b32 v24, v9, v8, s54
    v_perm_b32 v25, v11, v10, s54
    v_perm_b32 v26, v13, v12, s54
    v_perm_b32 v27, v15, v14, s54
    v_perm_b32 v24, v25, v24, s55
    v_perm_b32 v26, v27, v26, s55
    v_cmp_ne_u32 vcc, s63, v24
    v_cmp_ne_u32 s[42:43], s63, v26
    s_nop 0
    s_or_b64 vcc, vcc, s[42:43]
    s_cbranch_scc0 L_H4
    s_sub_u32 s62, s62, 1
    s_cbranch_scc1 L_H4
    global_load_dwordx4 v[8:11], v130, s[36:37] sc1
    global_load_dwordx4 v[12:15], v131, s[36:37] sc1
    s_branch L_H3
L_H4:
    v_and_b32 v8, s56, v8
    v_and_b32 v9, s56, v9
    v_and_b32 v10, s56, v10
    v_and_b32 v11, s56, v11
    v_and_b32 v12, s56, v12
    v_and_b32 v13, s56, v13
    v_and_b32 v14, s56, v14
    v_and_b32 v15, s56, v15
    v_pk_add_f32 v[8:9], v[8:9], v[12:13]
    v_pk_add_f32 v[10:11], v[10:11], v[14:15]
    s_nop 1
    v_permlane32_swap_b32 v8, v10
    v_permlane32_swap_b32 v9, v11
    v_pk_add_f32 v[8:9], v[8:9], v[10:11]
    s_nop 1
    v_permlane16_swap_b32 v8, v9
    v_add_f32 v8, v8, v9
    s_nop 1
    v_add_f32 v8, v8, v8 row_ror:8 row_mask:0xf bank_mask:0xf
    v_cvt_pk_bf16_f32 v8, v8, v8
    v_lshlrev_b32 v8, 16, v8
    v_mul_f32 v8, v8, v31
    v_cvt_pk_bf16_f32 v8, v8, v8
    v_lshlrev_b32 v8, 16, v8
    v_add_f32 v8, v125, v8
    v_cvt_pk_bf16_f32 v8, v8, v8
    s_mov_b64 exec, s[60:61]
    global_store_short v124, v8, s[22:23]
    s_add_u32 s3, s2, s28
    s_cmpk_lg_u32 s3, 144
    s_cbranch_scc1 L_P_noEp
    s_mov_b64 exec, 1
    v_mov_b32 v3, 819200
    global_store_dword v3, v93, s[26:27] sc1
L_P_noEp:
    s_mov_b64 exec, -1
    s_branch L_W_done
.p2align 6
L_O:
    s_sub_u32 s40, s30, 26
    s_cmp_ge_u32 s40, 3
    s_cselect_b32 s41, 1, 0
    s_cselect_b32 s3, 3, 0
    s_sub_u32 s48, s40, s3
    s_lshl1_add_u32 s52, s29, s41
    s_mul_i32 s50, s52, 294912
    s_mul_i32 s3, s48, 384
    s_sub_u32 s34, 294912, s3
    s_add_u32 s50, s50, s3
    s_waitcnt lgkmcnt(0)
    s_load_dword s63, s[26:27], 819200
    s_add_u32 s32, s12, s50
    s_addc_u32 s33, s13, 0
    global_load_dwordx4 v[72:75], v67, s[4:5]
    global_load_dwordx4 v[76:79], v67, s[4:5] offset:512
    global_load_dword v80, v68, s[4:5] offset:1024
    s_mov_b32 s54, 0
    s_lshl_b32 s55, s28, 4
    s_add_u32 s56, s55, 12288
L_dma_80:
    s_mov_b32 m0, s55
    s_add_u32 s55, s55, 4096
    buffer_load_dwordx4 v66, s[32:35], s54 offen nt lds
    s_add_u32 s54, s54, 36864
L_dmd_81:
    s_cmp_lt_u32 s55, s56
    s_cbranch_scc1 L_dma_80
    s_waitcnt lgkmcnt(0)
    s_barrier
    s_mul_i32 s63, s63, 0x9e3779b1
    s_add_u32 s63, s63, 0x7f4a7c15
    s_getreg_b32 s3, hwreg(HW_REG_XCC_ID, 0, 4)
    s_and_b32 s57, s63, -16
    s_or_b32 s57, s57, s3
    s_cmp_lg_u32 s28, 0
    s_cbranch_scc1 L_nocO
    s_lshl_b32 s3, s29, 5
    s_add_u32 s3, s3, s30
    s_lshl_b32 s3, s3, 2
    s_add_u32 s3, s3, 823296
    v_mov_b32 v3, s3
    v_mov_b32 v2, s57
    s_mov_b64 exec, 1
    global_store_dword v3, v2, s[26:27]
    s_mov_b64 exec, -1
L_nocO:
    s_add_u32 s56, s55, 20480
L_dma_82:
    s_mov_b32 m0, s55
    s_add_u32 s55, s55, 4096
    buffer_load_dwordx4 v66, s[32:35], s54 offen nt lds
    s_add_u32 s54, s54, 36864
L_dmd_83:
    s_cmp_lt_u32 s55, s56
    s_cbranch_scc1 L_dma_82
    s_mov_b32 s54, 128
    s_lshl_b32 s55, s28, 4
    s_add_u32 s55, s55, 32768
    s_add_u32 s56, s55, 32768
L_dma_84:
    s_mov_b32 m0, s55
    s_add_u32 s55, s55, 4096
    buffer_load_dwordx4 v66, s[32:35], s54 offen nt lds
    s_add_u32 s54, s54, 36864
L_dmd_85:
    s_cmp_lt_u32 s55, s56
    s_cbranch_scc1 L_dma_84
    s_mov_b32 s54, 256
    s_lshl_b32 s55, s28, 4
    s_add_u32 s55, s55, 65536
    s_add_u32 s56, s55, 32768
L_dma_86:
    s_mov_b32 m0, s55
    s_add_u32 s55, s55, 4096
    buffer_load_dwordx4 v66, s[32:35], s54 offen nt lds
    s_add_u32 s54, s54, 36864
L_dmd_87:
    s_cmp_lt_u32 s55, s56
    s_cbranch_scc1 L_dma_86
    v_mov_b32 v69, 1
    s_mov_b64 exec, 1
    ds_add_u32 v64, v69 offset:28
    s_mov_b64 exec, -1
    s_mov_b32 s60, 0x00ff00ff
    s_mov_b32 s61, s60
    v_mov_b32 v93, s63
    v_mov_b32 v95, s63
    v_mov_b32 v120, s63
    v_lshrrev_b32 v121, 8, v120
    v_lshrrev_b32 v122, 16, v120
    v_lshrrev_b32 v123, 24, v120
    s_cmp_lg_u32 s28, 0
    s_cbranch_scc1 L_noqO
    s_bfe_u32 s31, s2, 0x30004
    s_bfe_u32 s3, s2, 0x10003
    s_lshl1_add_u32 s58, s29, s3
    s_lshl3_add_u32 s3, s58, s31
    s_lshl_b32 s3, s3, 10
    v_lshl_add_u32 v5, v1, 4, s3
    v_lshlrev_b32 v4, 3, v1
    v_add_u32 v4, 124928, v4
    s_mov_b32 s62, 0x400000
L_spin_88:
    ds_read_b32 v3, v64 offset:32
    s_sub_u32 s62, s62, 1
    s_cbranch_scc1 L_spun_89
    s_waitcnt lgkmcnt(0)
    v_readfirstlane_b32 s3, v3
    s_nop 0
    s_cmp_lt_u32 s3, 1
    s_cbranch_scc1 L_spin_88
L_spun_89:
    s_waitcnt lgkmcnt(0)
    s_mov_b32 s62, 0x20000
L_poll_90:
    global_load_dwordx4 v[8:11], v5, s[26:27] sc1
    s_sub_u32 s62, s62, 1
    s_cbranch_scc1 L_polled_91
    s_waitcnt vmcnt(0)
    v_xor_b32 v3, s63, v9
    v_xor_b32 v2, s63, v11
    v_or_b32 v3, v3, v2
    v_cmp_ne_u32 vcc, 0, v3
    s_cbranch_vccnz L_poll_90
L_polled_91:
    s_waitcnt vmcnt(0)
    ds_write2_b32 v4, v8, v10 offset1:1
    s_mov_b64 exec, 1
    ds_add_u32 v64, v69 offset:36
    s_mov_b64 exec, -1
L_noqO:
    v_lshrrev_b32 v4, 4, v1
    v_bfe_u32 v5, v0, 2, 2
    v_lshrrev_b32 v26, 5, v0
    v_and_b32 v26, 6, v26
    v_bfe_u32 v27, v0, 1, 1
    v_or_b32 v26, v26, v27
    v_and_b32 v27, 1, v0
    v_lshlrev_b32 v6, 1, v4
    v_lshl_add_u32 v6, v5, 3, v6
    v_and_b32 v7, 1, v4
    v_and_b32 v5, 1, v5
    v_lshlrev_b32 v7, 1, v7
    v_lshl_or_b32 v7, v5, 2, v7
    v_xor_b32 v7, v7, v26
    v_lshlrev_b32 v7, 4, v7
    v_lshl_add_u32 v7, v27, 3, v7
    v_lshl_add_u32 v81, v6, 7, v7
    v_add_u32 v82, 0x10000, v81
    v_and_b32 v5, 15, v0
    s_movk_i32 s3, 544
    v_mul_u32_u24 v6, s3, v5
    v_lshl_add_u32 v6, v4, 4, v6
    v_add_u32 v88, 134016, v6
    s_mul_i32 s3, s28, 34
    s_add_u32 s3, s3, 134016
    v_lshl_add_u32 v89, v1, 3, s3
    v_add_u32 v90, 1088, v89
    s_lshl_b32 s3, s52, 14
    s_lshl_b32 s54, s28, 6
    s_add_u32 s3, s3, s54
    s_add_u32 s3, s3, 524288
    v_lshl_add_u32 v91, v1, 4, s3
    s_lshl_b32 s3, s52, 9
    s_add_u32 s3, s3, 786432
    v_lshl_add_u32 v87, v5, 5, s3
    v_and_b32 v5, 7, v0
    v_lshlrev_b32 v84, 6, v5
    v_lshl_add_u32 v84, v4, 4, v84
    s_mul_i32 s3, s48, 96
    s_add_u32 s3, s3, s52
    s_lshl_b32 s3, s3, 11
    s_lshl_b32 s54, s28, 3
    s_add_u32 s3, s3, s54
    s_add_u32 s3, s3, 851968
    v_add_u32 v84, s3, v84
    v_add_u32 v85, 65536, v84
    v_add_u32 v86, 131072, v84
    v_and_b32 v4, 0x1ff, v84
    s_lshl_b32 s49, s52, 9
    s_mul_i32 s54, s48, 12
    s_lshr_b32 s3, s28, 6
    s_add_u32 s54, s54, s3
    s_add_u32 s54, s54, 0
    s_cmp_ge_u32 s54, 18
    s_cselect_b32 s55, 18, 0
    s_sub_u32 s3, s54, s55
    s_cmp_ge_u32 s54, 18
    s_cselect_b32 s55, 8192, 0
    s_lshl_b32 s3, s3, 15
    s_add_u32 s3, s3, s55
    s_add_u32 s3, s3, 851968
    s_add_u32 s3, s3, s49
    v_add_u32 v84, s3, v4
    s_mul_i32 s54, s48, 12
    s_lshr_b32 s3, s28, 6
    s_add_u32 s54, s54, s3
    s_add_u32 s54, s54, 4
    s_cmp_ge_u32 s54, 18
    s_cselect_b32 s55, 18, 0
    s_sub_u32 s3, s54, s55
    s_cmp_ge_u32 s54, 18
    s_cselect_b32 s55, 8192, 0
    s_lshl_b32 s3, s3, 15
    s_add_u32 s3, s3, s55
    s_add_u32 s3, s3, 851968
    s_add_u32 s3, s3, s49
    v_add_u32 v85, s3, v4
    s_mul_i32 s54, s48, 12
    s_lshr_b32 s3, s28, 6
    s_add_u32 s54, s54, s3
    s_add_u32 s54, s54, 8
    s_cmp_ge_u32 s54, 18
    s_cselect_b32 s55, 18, 0
    s_sub_u32 s3, s54, s55
    s_cmp_ge_u32 s54, 18
    s_cselect_b32 s55, 8192, 0
    s_lshl_b32 s3, s3, 15
    s_add_u32 s3, s3, s55
    s_add_u32 s3, s3, 851968
    s_add_u32 s3, s3, s49
    v_add_u32 v86, s3, v4
    s_waitcnt vmcnt(0)
    s_mov_b64 exec, 1
    ds_add_u32 v64, v69 offset:0
    s_mov_b64 exec, -1
    s_mov_b32 s62, 0x400000
L_spin_92:
    ds_read_b32 v3, v64 offset:0
    s_sub_u32 s62, s62, 1
    s_cbranch_scc1 L_spun_93
    s_waitcnt lgkmcnt(0)
    v_readfirstlane_b32 s3, v3
    s_nop 0
    s_cmp_lt_u32 s3, 4
    s_cbranch_scc1 L_spin_92
L_spun_93:
    s_waitcnt lgkmcnt(0)
    ds_read_b64_tr_b16 v[140:141], v81 offset:0
    ds_read_b64_tr_b16 v[142:143], v81 offset:128
    ds_read_b64_tr_b16 v[144:145], v81 offset:16384
    ds_read_b64_tr_b16 v[146:147], v81 offset:16512
    ds_read_b64_tr_b16 v[148:149], v81 offset:4096
    ds_read_b64_tr_b16 v[150:151], v81 offset:4224
    ds_read_b64_tr_b16 v[152:153], v81 offset:20480
    ds_read_b64_tr_b16 v[154:155], v81 offset:20608
    s_waitcnt lgkmcnt(0)
    ds_read_b64_tr_b16 v[156:157], v81 offset:8192
    ds_read_b64_tr_b16 v[158:159], v81 offset:8320
    ds_read_b64_tr_b16 v[160:161], v81 offset:24576
    ds_read_b64_tr_b16 v[162:163], v81 offset:24704
    ds_read_b64_tr_b16 v[164:165], v81 offset:12288
    ds_read_b64_tr_b16 v[166:167], v81 offset:12416
    ds_read_b64_tr_b16 v[168:169], v81 offset:28672
    ds_read_b64_tr_b16 v[170:171], v81 offset:28800
    s_waitcnt lgkmcnt(0)
    ds_read_b64_tr_b16 v[172:173], v81 offset:32768
    ds_read_b64_tr_b16 v[174:175], v81 offset:32896
    ds_read_b64_tr_b16 v[176:177], v81 offset:49152
    ds_read_b64_tr_b16 v[178:179], v81 offset:49280
    ds_read_b64_tr_b16 v[180:181], v81 offset:36864
    ds_read_b64_tr_b16 v[182:183], v81 offset:36992
    ds_read_b64_tr_b16 v[184:185], v81 offset:53248
    ds_read_b64_tr_b16 v[186:187], v81 offset:53376
    s_waitcnt lgkmcnt(0)
    ds_read_b64_tr_b16 v[188:189], v81 offset:40960
    ds_read_b64_tr_b16 v[190:191], v81 offset:41088
    ds_read_b64_tr_b16 v[192:193], v81 offset:57344
    ds_read_b64_tr_b16 v[194:195], v81 offset:57472
    ds_read_b64_tr_b16 v[196:197], v81 offset:45056
    ds_read_b64_tr_b16 v[198:199], v81 offset:45184
    ds_read_b64_tr_b16 v[200:201], v81 offset:61440
    ds_read_b64_tr_b16 v[202:203], v81 offset:61568
    s_waitcnt lgkmcnt(0)
    ds_read_b64_tr_b16 v[204:205], v82 offset:0
    ds_read_b64_tr_b16 v[206:207], v82 offset:128
    ds_read_b64_tr_b16 v[208:209], v82 offset:16384
    ds_read_b64_tr_b16 v[210:211], v82 offset:16512
    ds_read_b64_tr_b16 v[212:213], v82 offset:4096
    ds_read_b64_tr_b16 v[214:215], v82 offset:4224
    ds_read_b64_tr_b16 v[216:217], v82 offset:20480
    ds_read_b64_tr_b16 v[218:219], v82 offset:20608
    s_waitcnt lgkmcnt(0)
    ds_read_b64_tr_b16 v[220:221], v82 offset:8192
    ds_read_b64_tr_b16 v[222:223], v82 offset:8320
    ds_read_b64_tr_b16 v[224:225], v82 offset:24576
    ds_read_b64_tr_b16 v[226:227], v82 offset:24704
    ds_read_b64_tr_b16 v[228:229], v82 offset:12288
    ds_read_b64_tr_b16 v[230:231], v82 offset:12416
    ds_read_b64_tr_b16 v[232:233], v82 offset:28672
    ds_read_b64_tr_b16 v[234:235], v82 offset:28800
    s_waitcnt lgkmcnt(0)
    s_mov_b32 s62, 0x400000
L_spin_94:
    ds_read_b32 v3, v64 offset:8
    s_sub_u32 s62, s62, 1
    s_cbranch_scc1 L_spun_95
    s_waitcnt lgkmcnt(0)
    v_readfirstlane_b32 s3, v3
    s_nop 0
    s_cmp_lt_u32 s3, 4
    s_cbranch_scc1 L_spin_94
L_spun_95:
    s_waitcnt lgkmcnt(0)
    s_mov_b32 s62, 0x20000
L_poll_96:
    global_load_dwordx4 v[8:11], v87, s[26:27] sc1
    global_load_dwordx4 v[12:15], v87, s[26:27] offset:16 sc1
    s_sub_u32 s62, s62, 1
    s_cbranch_scc1 L_polled_97
    s_waitcnt vmcnt(0)
    v_xor_b32 v3, s63, v9
    v_xor_b32 v2, s63, v11
    v_bitop3_b32 v3, v13, s63, v3 bitop3:0xbe
    v_bitop3_b32 v2, v15, s63, v2 bitop3:0xbe
    v_or_b32 v3, v3, v2
    v_cmp_ne_u32 vcc, 0, v3
    s_cbranch_vccnz L_poll_96
L_polled_97:
    s_waitcnt vmcnt(0)
    s_mov_b32 s55, 0x3fb8aa3b
    s_movk_i32 s56, 0xff
    v_max_f32 v16, v8, v8 row_ror:8 row_mask:0xf bank_mask:0xf
    v_sub_f32 v16, v8, v16
    v_mul_f32 v16, s55, v16
    v_exp_f32 v16, v16
    s_nop 0
    v_mul_f32 v16, v16, v10
    s_nop 1
    v_add_f32 v17, v16, v16 row_ror:8 row_mask:0xf bank_mask:0xf
    v_rcp_f32 v17, v17
    s_nop 0
    v_mul_f32 v60, v16, v17
    v_max_f32 v16, v12, v12 row_ror:8 row_mask:0xf bank_mask:0xf
    v_sub_f32 v16, v12, v16
    v_mul_f32 v16, s55, v16
    v_exp_f32 v16, v16
    s_nop 0
    v_mul_f32 v16, v16, v14
    s_nop 1
    v_add_f32 v17, v16, v16 row_ror:8 row_mask:0xf bank_mask:0xf
    v_rcp_f32 v17, v17
    s_nop 0
    v_mul_f32 v61, v16, v17
    s_mov_b32 s62, 0x400000
L_spin_98:
    ds_read_b32 v3, v64 offset:40
    s_sub_u32 s62, s62, 1
    s_cbranch_scc1 L_spun_99
    s_waitcnt lgkmcnt(0)
    v_readfirstlane_b32 s3, v3
    s_nop 0
    s_cmp_lt_u32 s3, 1
    s_cbranch_scc1 L_spin_98
L_spun_99:
    s_waitcnt lgkmcnt(0)
    s_mov_b32 s62, 0x20000
L_X1l0:
    global_load_dwordx4 v[8:11], v91, s[26:27] offset:0 sc1
    global_load_dwordx4 v[12:15], v91, s[26:27] offset:1024 sc1
    global_load_dwordx4 v[16:19], v91, s[26:27] offset:2048 sc1
    global_load_dwordx4 v[20:23], v91, s[26:27] offset:3072 sc1
    s_sub_u32 s62, s62, 1
    s_cbranch_scc1 L_X1e
    s_waitcnt vmcnt(0)
L_X1c0:
    v_cmp_ne_u32 vcc, s63, v9
    v_cmp_ne_u32 s[42:43], s63, v11
    ds_write2_b32 v89, v8, v10 offset0:0 offset1:1
    s_or_b64 vcc, vcc, s[42:43]
    s_cbranch_scc1 L_X1l0
    s_branch L_X1c1
L_X1l1:
    global_load_dwordx4 v[12:15], v91, s[26:27] offset:1024 sc1
    global_load_dwordx4 v[16:19], v91, s[26:27] offset:2048 sc1
    global_load_dwordx4 v[20:23], v91, s[26:27] offset:3072 sc1
    s_sub_u32 s62, s62, 1
    s_cbranch_scc1 L_X1e
    s_waitcnt vmcnt(0)
L_X1c1:
    v_cmp_ne_u32 vcc, s63, v13
    v_cmp_ne_u32 s[42:43], s63, v15
    ds_write2_b32 v89, v12, v14 offset0:136 offset1:137
    s_or_b64 vcc, vcc, s[42:43]
    s_cbranch_scc1 L_X1l1
    s_branch L_X1c2
L_X1l2:
    global_load_dwordx4 v[16:19], v91, s[26:27] offset:2048 sc1
    global_load_dwordx4 v[20:23], v91, s[26:27] offset:3072 sc1
    s_sub_u32 s62, s62, 1
    s_cbranch_scc1 L_X1e
    s_waitcnt vmcnt(0)
L_X1c2:
    v_cmp_ne_u32 vcc, s63, v17
    v_cmp_ne_u32 s[42:43], s63, v19
    ds_write2_b32 v90, v16, v18 offset0:0 offset1:1
    s_or_b64 vcc, vcc, s[42:43]
    s_cbranch_scc1 L_X1l2
    s_branch L_X1c3
L_X1l3:
    global_load_dwordx4 v[20:23], v91, s[26:27] offset:3072 sc1
    s_sub_u32 s62, s62, 1
    s_cbranch_scc1 L_X1e
    s_waitcnt vmcnt(0)
L_X1c3:
    v_cmp_ne_u32 vcc, s63, v21
    v_cmp_ne_u32 s[42:43], s63, v23
    ds_write2_b32 v90, v20, v22 offset0:136 offset1:137
    s_or_b64 vcc, vcc, s[42:43]
    s_cbranch_scc1 L_X1l3
L_X1e:
    s_waitcnt vmcnt(0)
    s_waitcnt lgkmcnt(0)
    s_barrier
    ds_read_b128 v[8:11], v88 offset:0
    ds_read_b128 v[12:15], v88 offset:64
    ds_read_b128 v[16:19], v88 offset:128
    ds_read_b128 v[20:23], v88 offset:192
    ds_read_b128 v[24:27], v88 offset:256
    ds_read_b128 v[28:31], v88 offset:320
    ds_read_b128 v[32:35], v88 offset:384
    ds_read_b128 v[36:39], v88 offset:448
    s_waitcnt lgkmcnt(7)
    v_mfma_f32_16x16x32_bf16 v[96:99], v[140:143], v[8:11], 0
    s_waitcnt lgkmcnt(6)
    v_mfma_f32_16x16x32_bf16 v[100:103], v[144:147], v[12:15], 0
    s_waitcnt lgkmcnt(5)
    v_mfma_f32_16x16x32_bf16 v[96:99], v[148:151], v[16:19], v[96:99]
    s_waitcnt lgkmcnt(4)
    v_mfma_f32_16x16x32_bf16 v[100:103], v[152:155], v[20:23], v[100:103]
    s_waitcnt lgkmcnt(3)
    v_mfma_f32_16x16x32_bf16 v[96:99], v[156:159], v[24:27], v[96:99]
    s_waitcnt lgkmcnt(2)
    v_mfma_f32_16x16x32_bf16 v[100:103], v[160:163], v[28:31], v[100:103]
    s_waitcnt lgkmcnt(1)
    v_mfma_f32_16x16x32_bf16 v[96:99], v[164:167], v[32:35], v[96:99]
    s_waitcnt lgkmcnt(0)
    v_mfma_f32_16x16x32_bf16 v[100:103], v[168:171], v[36:39], v[100:103]
    v_mfma_f32_16x16x32_bf16 v[104:107], v[172:175], v[8:11], 0
    v_mfma_f32_16x16x32_bf16 v[108:111], v[176:179], v[12:15], 0
    v_mfma_f32_16x16x32_bf16 v[104:107], v[180:183], v[16:19], v[104:107]
    s_nop 2
    v_pk_mul_f32 v[96:97], v[96:97], v[60:61] op_sel_hi:[1,0]
    v_pk_mul_f32 v[98:99], v[98:99], v[60:61] op_sel_hi:[1,0]
    v_pk_fma_f32 v[96:97], v[100:101], v[60:61], v[96:97] op_sel:[0,1,0] op_sel_hi:[1,1,1]
    v_mfma_f32_16x16x32_bf16 v[108:111], v[184:187], v[20:23], v[108:111]
    v_pk_fma_f32 v[98:99], v[102:103], v[60:61], v[98:99] op_sel:[0,1,0] op_sel_hi:[1,1,1]
    v_add_f32 v96, v96, v96 row_ror:8 row_mask:0xf bank_mask:0xf
    v_add_f32 v97, v97, v97 row_ror:8 row_mask:0xf bank_mask:0xf
    v_mfma_f32_16x16x32_bf16 v[104:107], v[188:191], v[24:27], v[104:107]
    v_add_f32 v98, v98, v98 row_ror:8 row_mask:0xf bank_mask:0xf
    v_add_f32 v99, v99, v99 row_ror:8 row_mask:0xf bank_mask:0xf
    v_add_u32 v96, 0x80, v96
    v_mfma_f32_16x16x32_bf16 v[108:111], v[192:195], v[28:31], v[108:111]
    v_add_u32 v97, 0x80, v97
    v_add_u32 v98, 0x80, v98
    v_add_u32 v99, 0x80, v99
    v_mfma_f32_16x16x32_bf16 v[104:107], v[196:199], v[32:35], v[104:107]
    v_bfi_b32 v96, s56, v120, v96
    v_bfi_b32 v97, s56, v121, v97
    v_bfi_b32 v98, s56, v122, v98
    v_mfma_f32_16x16x32_bf16 v[108:111], v[200:203], v[36:39], v[108:111]
    v_bfi_b32 v99, s56, v123, v99
    s_mov_b64 exec, s[60:61]
    global_store_dwordx4 v84, v[96:99], s[26:27] sc1
    s_mov_b64 exec, -1
    v_mfma_f32_16x16x32_bf16 v[112:115], v[204:207], v[8:11], 0
    v_mfma_f32_16x16x32_bf16 v[116:119], v[208:211], v[12:15], 0
    v_mfma_f32_16x16x32_bf16 v[112:115], v[212:215], v[16:19], v[112:115]
    v_pk_mul_f32 v[104:105], v[104:105], v[60:61] op_sel_hi:[1,0]
    v_pk_mul_f32 v[106:107], v[106:107], v[60:61] op_sel_hi:[1,0]
    v_pk_fma_f32 v[104:105], v[108:109], v[60:61], v[104:105] op_sel:[0,1,0] op_sel_hi:[1,1,1]
    v_mfma_f32_16x16x32_bf16 v[116:119], v[216:219], v[20:23], v[116:119]
    v_pk_fma_f32 v[106:107], v[110:111], v[60:61], v[106:107] op_sel:[0,1,0] op_sel_hi:[1,1,1]
    v_add_f32 v104, v104, v104 row_ror:8 row_mask:0xf bank_mask:0xf
    v_add_f32 v105, v105, v105 row_ror:8 row_mask:0xf bank_mask:0xf
    v_mfma_f32_16x16x32_bf16 v[112:115], v[220:223], v[24:27], v[112:115]
    v_add_f32 v106, v106, v106 row_ror:8 row_mask:0xf bank_mask:0xf
    v_add_f32 v107, v107, v107 row_ror:8 row_mask:0xf bank_mask:0xf
    v_add_u32 v104, 0x80, v104
    v_mfma_f32_16x16x32_bf16 v[116:119], v[224:227], v[28:31], v[116:119]
    v_add_u32 v105, 0x80, v105
    v_add_u32 v106, 0x80, v106
    v_add_u32 v107, 0x80, v107
    v_mfma_f32_16x16x32_bf16 v[112:115], v[228:231], v[32:35], v[112:115]
    v_bfi_b32 v104, s56, v120, v104
    v_bfi_b32 v105, s56, v121, v105
    v_bfi_b32 v106, s56, v122, v106
    v_mfma_f32_16x16x32_bf16 v[116:119], v[232:235], v[36:39], v[116:119]
    v_bfi_b32 v107, s56, v123, v107
    s_mov_b64 exec, s[60:61]
    global_store_dwordx4 v85, v[104:107], s[26:27] sc1
    s_mov_b64 exec, -1
    v_pk_mul_f32 v[112:113], v[112:113], v[60:61] op_sel_hi:[1,0]
    v_pk_mul_f32 v[114:115], v[114:115], v[60:61] op_sel_hi:[1,0]
    s_nop 1
    v_pk_fma_f32 v[112:113], v[116:117], v[60:61], v[112:113] op_sel:[0,1,0] op_sel_hi:[1,1,1]
    v_pk_fma_f32 v[114:115], v[118:119], v[60:61], v[114:115] op_sel:[0,1,0] op_sel_hi:[1,1,1]
    s_nop 0
    v_add_f32 v112, v112, v112 row_ror:8 row_mask:0xf bank_mask:0xf
    v_add_f32 v113, v113, v113 row_ror:8 row_mask:0xf bank_mask:0xf
    v_add_f32 v114, v114, v114 row_ror:8 row_mask:0xf bank_mask:0xf
    v_add_f32 v115, v115, v115 row_ror:8 row_mask:0xf bank_mask:0xf
    v_add_u32 v112, 0x80, v112
    v_add_u32 v113, 0x80, v113
    v_add_u32 v114, 0x80, v114
    v_add_u32 v115, 0x80, v115
    v_bfi_b32 v112, s56, v120, v112
    v_bfi_b32 v113, s56, v121, v113
    v_bfi_b32 v114, s56, v122, v114
    v_bfi_b32 v115, s56, v123, v115
    s_mov_b64 exec, s[60:61]
    global_store_dwordx4 v86, v[112:115], s[26:27] sc1
    s_mov_b64 exec, -1
L_W_done:
L_end:
    s_endpgm
.fill (16384 + 256 - (. - recurrent_scan__sliding_block_cached__glu_gated_bilinear__decode_kernel)) / 4, 4, 0xbf810000
.section .rodata,"a"
.p2align 6
.amdhsa_kernel recurrent_scan__sliding_block_cached__glu_gated_bilinear__decode_kernel
  .amdhsa_next_free_vgpr 256
  .amdhsa_next_free_sgpr 96
  .amdhsa_accum_offset 256
  .amdhsa_group_segment_fixed_size 0
  .amdhsa_kernarg_size 96
  .amdhsa_user_sgpr_count 2
  .amdhsa_user_sgpr_kernarg_segment_ptr 1
  .amdhsa_system_sgpr_workgroup_id_x 1
  .amdhsa_float_denorm_mode_32 3
.end_amdhsa_kernel
```
